```python
import torch

def _softmax(x, axis=-1):
    return torch.softmax(x, dim=axis)
def _gelu(x):
    return torch.nn.functional.gelu(x, approximate="tanh")
def _silu(x):
    return torch.nn.functional.silu(x)
def _sigmoid(x):
    return torch.sigmoid(x)
def _layernorm(x, axis=-1, eps=1e-5):
    m = x.mean(dim=axis, keepdim=True)
    v = x.var(dim=axis, keepdim=True, unbiased=False)
    return (x - m) / torch.sqrt(v + eps)
def _scatter_add(tgt, idx, src, axis=0):
    return tgt.clone().index_add_(axis, idx, src)
def _segment_sum(src, seg, n):
    out = torch.zeros((n,) + src.shape[1:], dtype=src.dtype)
    return out.index_add_(0, seg, src)
def _pad(x, pw):
    flat = tuple(v for pair in reversed(pw) for v in pair)
    return torch.nn.functional.pad(x, flat)

kernel_name = 'standalone__mha_softmax__sampling'

def setup_inputs():

    _w = (lambda a: (lambda t: t.to(torch.bfloat16) if t.is_floating_point() else t)(torch.as_tensor(a)))
    B, H, Sq, Sk, D = 8, 32, 1, 4096, 192
    return {
        "q": _w((lambda *s: torch.randn(*s, dtype=torch.bfloat16) * 0.8)(B, H, Sq, D)),
        "k": _w((lambda *s: torch.randn(*s, dtype=torch.bfloat16) * 0.8)(B, H, Sk, D)),
        "v": _w((lambda *s: torch.randn(*s, dtype=torch.bfloat16) * 0.05)(B, H, Sk, D)),
    }

def reference(q, k, v):
    scale = q.shape[-1] ** -0.5
    scores = torch.einsum("bhqd,bhkd->bhqk", q, k) * scale
    p = _softmax(scores, axis=-1)
    return torch.einsum("bhqk,bhkd->bhqd", p, v)
```

```asm
; @launch grid=(256,1,1) block=(256,1,1) lds=49184
.amdgcn_target "amdgcn-amd-amdhsa--gfx950"
.text
.globl standalone__mha_softmax__sampling_kernel
.p2align 8
.type standalone__mha_softmax__sampling_kernel,@function
standalone__mha_softmax__sampling_kernel:
  s_cmp_ge_u32 s2, 256
  s_cbranch_scc1 L_done
  s_load_dwordx4 s[4:7], s[0:1], 0
  s_load_dwordx4 s[8:11], s[0:1], 16
  s_load_dwordx2 s[84:85], s[0:1], 32
  v_lshrrev_b32 v3, 6, v0
  v_and_b32 v1, 63, v0
  v_readfirstlane_b32 s48, v3
  v_bfe_u32 v37, v0, 3, 3
  v_lshlrev_b32 v1, 4, v1
  v_mul_u32_u24 v36, 12288, v3
  v_lshl_add_u32 v36, v37, 2, v36
  v_mul_u32_u24 v34, 11, v37
  v_lshrrev_b32 v34, 5, v34
  v_mul_u32_u24 v34, 3, v34
  v_sub_u32 v34, v37, v34
  v_and_b32 v3, 7, v0
  v_lshlrev_b32 v2, 4, v3
  v_lshl_add_u32 v48, v34, 7, v2
  v_add_u32 v50, 128, v48
  v_add_u32 v49, 256, v48
  v_mov_b32 v35, 384
  v_cmp_le_u32 vcc, v35, v50
  v_subrev_u32 v51, 384, v50
  s_and_b32 s38, s2, 7
  v_cndmask_b32 v50, v50, v51, vcc
  v_cmp_le_u32 vcc, v35, v49
  v_subrev_u32 v51, 384, v49
  s_lshr_b32 s39, s2, 3
  v_cndmask_b32 v49, v49, v51, vcc
  s_mov_b32 s45, s2
  s_mul_i32 s38, s38, 0
  s_mul_i32 s39, s39, 4
  s_add_u32 s38, s38, s39
  s_lshl_b32 s38, s38, 1
  s_and_b32 s39, s48, 1
  s_or_b32 s32, s38, s39
  s_and_b32 s32, s32, 255
  s_cmp_ge_u32 s48, 2
  s_cselect_b32 s33, 11, 0
  s_cselect_b32 s34, 10, 11
  s_cselect_b32 s35, 11, 10
  s_cselect_b32 s36, 21, 22
  s_cselect_b32 s37, 10, 11
  s_mov_b32 s46, s32
  s_and_b32 s38, s32, 31
  s_andn2_b32 s39, s32, 31
  s_lshl_b32 s39, s39, 1
  s_add_u32 s39, s39, s38
  s_add_u32 s39, s39, s33
  s_cmp_ge_u32 s38, s34
  s_cselect_b32 s57, s35, 0
  s_add_u32 s39, s39, s57
  s_cmp_ge_u32 s38, s36
  s_cselect_b32 s57, s37, 0
  s_add_u32 s39, s39, s57
  s_mul_i32 s57, s39, 3072
  s_add_u32 s32, s32, 2
  s_and_b32 s32, s32, 255
  s_and_b32 s38, s32, 31
  s_andn2_b32 s39, s32, 31
  s_lshl_b32 s39, s39, 1
  s_add_u32 s39, s39, s38
  s_add_u32 s39, s39, s33
  s_cmp_ge_u32 s38, s34
  s_cselect_b32 s47, s35, 0
  s_add_u32 s39, s39, s47
  s_cmp_ge_u32 s38, s36
  s_cselect_b32 s47, s37, 0
  s_add_u32 s39, s39, s47
  s_mul_i32 s47, s39, 3072
  s_add_u32 s32, s32, 2
  s_and_b32 s32, s32, 255
  s_mul_i32 s29, s45, 1572864
  s_mul_i32 s49, s45, 384
  s_mov_b32 s14, 1572864
  s_mov_b32 s15, 0x20000
  s_mov_b32 s18, 1572864
  s_mov_b32 s19, 0x20000
  s_mov_b32 s22, 384
  s_mov_b32 s23, 0x20000
  s_mov_b32 s26, 384
  s_mov_b32 s27, 0x20000
  s_waitcnt lgkmcnt(0)
  s_add_u32 s12, s6, s29
  s_addc_u32 s13, s7, 0
  s_and_b32 s13, s13, 0xffff
  buffer_load_dwordx4 v[112:115], v1, s[12:15], s57 offen offset:0 nt
  s_add_u32 s20, s4, s49
  s_addc_u32 s21, s5, 0
  s_and_b32 s21, s21, 0xffff
  buffer_load_dwordx4 v[8:11], v48, s[20:23], 0 offen
  buffer_load_dwordx4 v[12:15], v49, s[20:23], 0 offen
  buffer_load_dwordx4 v[16:19], v50, s[20:23], 0 offen
  buffer_load_dwordx4 v[116:119], v1, s[12:15], s57 offen offset:1024 nt
  buffer_load_dwordx4 v[120:123], v1, s[12:15], s57 offen offset:2048 nt
  buffer_load_dwordx4 v[124:127], v1, s[12:15], s47 offen offset:0 nt
  buffer_load_dwordx4 v[128:131], v1, s[12:15], s47 offen offset:1024 nt
  buffer_load_dwordx4 v[132:135], v1, s[12:15], s47 offen offset:2048 nt
  s_add_u32 s16, s8, s29
  s_addc_u32 s17, s9, 0
  s_and_b32 s17, s17, 0xffff
  s_add_u32 s24, s10, s49
  s_addc_u32 s25, s11, 0
  s_and_b32 s25, s25, 0xffff
  s_and_b32 s85, s85, 0xffff
  s_mov_b32 s86, 256
  s_mov_b32 s87, 0x20000
  s_and_b32 s38, s2, 7
  s_lshl_b32 s38, s38, 5
  s_lshr_b32 s39, s2, 3
  s_add_u32 s39, s39, s38
  v_and_b32 v209, 63, v0
  v_mov_b32 v210, 0x1000
  v_cmp_gt_u32 vcc, 32, v209
  v_add_u32 v209, s38, v209
  v_mov_b32 v208, s39
  v_cndmask_b32 v209, v210, v209, vcc
  v_cmp_eq_u32 vcc, 0, v0
  s_mov_b32 s88, 0
  s_mov_b32 s89, 0
  v_cndmask_b32 v208, v210, v208, vcc
  s_mov_b32 s44, s89
  v_and_b32 v212, 63, v0
  v_lshlrev_b32 v212, 2, v212
  s_mov_b32 s91, 0
  s_and_b32 s92, s2, 7
  s_lshl_b32 s92, s92, 3
  v_and_b32 v37, 1, v0
  v_cmp_eq_u32 vcc, 1, v37
  v_mov_b32 v34, 0xffff
  v_mov_b32 v35, 0xffff0000
  v_cndmask_b32 v34, v34, v35, vcc
  v_bfe_u32 v37, v0, 4, 1
  v_bfe_u32 v35, v0, 5, 1
  v_cmp_eq_u32 vcc, v37, v35
  v_lshrrev_b32 v37, 1, v3
  s_nop 0
  v_cndmask_b32 v34, 0, v34, vcc
  v_cmp_eq_u32 vcc, 0, v37
  s_nop 1
  v_cndmask_b32 v4, 0, v34, vcc
  v_cmp_eq_u32 vcc, 1, v37
  s_nop 1
  v_cndmask_b32 v5, 0, v34, vcc
  v_cmp_eq_u32 vcc, 2, v37
  s_nop 1
  v_cndmask_b32 v6, 0, v34, vcc
  v_cmp_eq_u32 vcc, 3, v37
  s_nop 1
  v_cndmask_b32 v7, 0, v34, vcc
  v_bfe_u32 v37, v0, 4, 1
  v_bfe_u32 v35, v0, 3, 1
  v_add_u32 v38, v37, v35
  v_add3_u32 v39, v38, v37, 2
  v_lshrrev_b32 v37, 6, v0
  v_mul_u32_u24 v37, 12288, v37
  v_lshl_add_u32 v38, v38, 2, v37
  v_lshl_add_u32 v39, v39, 2, v37
  s_mov_b32 s31, 0x3dd53b95
  s_mov_b32 s64, 0xff000000
  s_mov_b32 s65, 0xff000000
  s_mov_b32 s66, 0xffff0000
  s_mov_b32 s67, 0xffff0000
  s_mov_b32 s68, 0xffffff00
  s_mov_b32 s69, 0xffffff00
  s_waitcnt vmcnt(5)
  v_mov_b32 v20, 0
  v_dot2c_f32_bf16 v20, v112, v8
  v_dot2c_f32_bf16 v20, v113, v9
  v_dot2c_f32_bf16 v20, v114, v10
  v_dot2c_f32_bf16 v20, v115, v11
  s_and_b32 s38, s32, 31
  s_andn2_b32 s39, s32, 31
  s_lshl_b32 s39, s39, 1
  s_add_u32 s39, s39, s38
  s_add_u32 s39, s39, s33
  s_cmp_ge_u32 s38, s34
  s_cselect_b32 s47, s35, 0
  s_add_u32 s39, s39, s47
  s_cmp_ge_u32 s38, s36
  s_cselect_b32 s47, s37, 0
  s_add_u32 s39, s39, s47
  s_mul_i32 s47, s39, 3072
  s_add_u32 s32, s32, 2
  s_and_b32 s32, s32, 255
  s_cmp_gt_u32 s44, 0
  s_cbranch_scc1 L_th1
  s_waitcnt vmcnt(4)
L_th1:
  buffer_load_dwordx4 v[136:139], v1, s[12:15], s47 offen offset:0 nt
  s_waitcnt vmcnt(5)
  v_mov_b32 v21, 0
  v_dot2c_f32_bf16 v21, v116, v12
  v_dot2c_f32_bf16 v21, v117, v13
  v_dot2c_f32_bf16 v21, v118, v14
  v_dot2c_f32_bf16 v21, v119, v15
  s_waitcnt vmcnt(4)
  buffer_load_dwordx4 v[140:143], v1, s[12:15], s47 offen offset:1024 nt
  v_add_f32_dpp v20, v20, v20 quad_perm:[1,0,3,2] row_mask:0xf bank_mask:0xf
  s_waitcnt vmcnt(5)
  v_mov_b32 v22, 0
  v_dot2c_f32_bf16 v22, v120, v16
  v_dot2c_f32_bf16 v22, v121, v17
  v_dot2c_f32_bf16 v22, v122, v18
  v_dot2c_f32_bf16 v22, v123, v19
  s_cmp_gt_u32 s44, 1
  s_cbranch_scc1 L_th2
  s_waitcnt vmcnt(4)
L_th2:
  buffer_load_dwordx4 v[144:147], v1, s[12:15], s47 offen offset:2048 nt
  v_add_f32_dpp v21, v21, v21 quad_perm:[1,0,3,2] row_mask:0xf bank_mask:0xf
  v_add_f32_dpp v20, v20, v20 quad_perm:[2,3,0,1] row_mask:0xf bank_mask:0xf
  s_waitcnt vmcnt(5)
  v_mov_b32 v23, 0
  v_dot2c_f32_bf16 v23, v124, v8
  v_dot2c_f32_bf16 v23, v125, v9
  v_dot2c_f32_bf16 v23, v126, v10
  v_dot2c_f32_bf16 v23, v127, v11
  s_and_b32 s38, s32, 31
  s_andn2_b32 s39, s32, 31
  s_lshl_b32 s39, s39, 1
  s_add_u32 s39, s39, s38
  s_add_u32 s39, s39, s33
  s_cmp_ge_u32 s38, s34
  s_cselect_b32 s47, s35, 0
  s_add_u32 s39, s39, s47
  s_cmp_ge_u32 s38, s36
  s_cselect_b32 s47, s37, 0
  s_add_u32 s39, s39, s47
  s_mul_i32 s47, s39, 3072
  s_add_u32 s32, s32, 2
  s_and_b32 s32, s32, 255
  s_waitcnt vmcnt(4)
  buffer_load_dwordx4 v[148:151], v1, s[12:15], s47 offen offset:0 nt
  v_add_f32_dpp v22, v22, v22 quad_perm:[1,0,3,2] row_mask:0xf bank_mask:0xf
  v_add_f32_dpp v21, v21, v21 quad_perm:[2,3,0,1] row_mask:0xf bank_mask:0xf
  v_add_f32_dpp v20, v20, v20 row_half_mirror row_mask:0xf bank_mask:0xf
  ds_write_b32 v36, v20 offset:0
  s_waitcnt vmcnt(5)
  v_mov_b32 v20, 0
  v_dot2c_f32_bf16 v20, v128, v12
  v_dot2c_f32_bf16 v20, v129, v13
  v_dot2c_f32_bf16 v20, v130, v14
  v_dot2c_f32_bf16 v20, v131, v15
  s_cmp_gt_u32 s44, 2
  s_cbranch_scc1 L_th3
  s_waitcnt vmcnt(4)
L_th3:
  buffer_load_dwordx4 v[152:155], v1, s[12:15], s47 offen offset:1024 nt
  v_add_f32_dpp v23, v23, v23 quad_perm:[1,0,3,2] row_mask:0xf bank_mask:0xf
  v_add_f32_dpp v22, v22, v22 quad_perm:[2,3,0,1] row_mask:0xf bank_mask:0xf
  v_add_f32_dpp v21, v21, v21 row_half_mirror row_mask:0xf bank_mask:0xf
  ds_write_b32 v36, v21 offset:32
  s_waitcnt vmcnt(5)
  v_mov_b32 v21, 0
  v_dot2c_f32_bf16 v21, v132, v16
  v_dot2c_f32_bf16 v21, v133, v17
  v_dot2c_f32_bf16 v21, v134, v18
  v_dot2c_f32_bf16 v21, v135, v19
  s_waitcnt vmcnt(4)
  buffer_load_dwordx4 v[156:159], v1, s[12:15], s47 offen offset:2048 nt
  v_add_f32_dpp v20, v20, v20 quad_perm:[1,0,3,2] row_mask:0xf bank_mask:0xf
  v_add_f32_dpp v23, v23, v23 quad_perm:[2,3,0,1] row_mask:0xf bank_mask:0xf
  v_add_f32_dpp v22, v22, v22 row_half_mirror row_mask:0xf bank_mask:0xf
  ds_write_b32 v36, v22 offset:64
  s_waitcnt vmcnt(5)
  v_mov_b32 v22, 0
  v_dot2c_f32_bf16 v22, v136, v8
  v_dot2c_f32_bf16 v22, v137, v9
  v_dot2c_f32_bf16 v22, v138, v10
  v_dot2c_f32_bf16 v22, v139, v11
  s_and_b32 s38, s32, 31
  s_andn2_b32 s39, s32, 31
  s_lshl_b32 s39, s39, 1
  s_add_u32 s39, s39, s38
  s_add_u32 s39, s39, s33
  s_cmp_ge_u32 s38, s34
  s_cselect_b32 s47, s35, 0
  s_add_u32 s39, s39, s47
  s_cmp_ge_u32 s38, s36
  s_cselect_b32 s47, s37, 0
  s_add_u32 s39, s39, s47
  s_mul_i32 s47, s39, 3072
  s_add_u32 s32, s32, 2
  s_and_b32 s32, s32, 255
  s_cmp_gt_u32 s44, 3
  s_cbranch_scc1 L_th4
  s_waitcnt vmcnt(4)
L_th4:
  buffer_load_dwordx4 v[160:163], v1, s[12:15], s47 offen offset:0 nt
  v_add_f32_dpp v21, v21, v21 quad_perm:[1,0,3,2] row_mask:0xf bank_mask:0xf
  v_add_f32_dpp v20, v20, v20 quad_perm:[2,3,0,1] row_mask:0xf bank_mask:0xf
  v_add_f32_dpp v23, v23, v23 row_half_mirror row_mask:0xf bank_mask:0xf
  ds_write_b32 v36, v23 offset:96
  s_waitcnt vmcnt(5)
  v_mov_b32 v23, 0
  v_dot2c_f32_bf16 v23, v140, v12
  v_dot2c_f32_bf16 v23, v141, v13
  v_dot2c_f32_bf16 v23, v142, v14
  v_dot2c_f32_bf16 v23, v143, v15
  s_waitcnt vmcnt(4)
  buffer_load_dwordx4 v[164:167], v1, s[12:15], s47 offen offset:1024 nt
  v_add_f32_dpp v22, v22, v22 quad_perm:[1,0,3,2] row_mask:0xf bank_mask:0xf
  v_add_f32_dpp v21, v21, v21 quad_perm:[2,3,0,1] row_mask:0xf bank_mask:0xf
  v_add_f32_dpp v20, v20, v20 row_half_mirror row_mask:0xf bank_mask:0xf
  ds_write_b32 v36, v20 offset:128
  s_waitcnt vmcnt(5)
  v_mov_b32 v20, 0
  v_dot2c_f32_bf16 v20, v144, v16
  v_dot2c_f32_bf16 v20, v145, v17
  v_dot2c_f32_bf16 v20, v146, v18
  v_dot2c_f32_bf16 v20, v147, v19
  s_cmp_gt_u32 s44, 4
  s_cbranch_scc1 L_th5
  s_waitcnt vmcnt(4)
L_th5:
  buffer_load_dwordx4 v[168:171], v1, s[12:15], s47 offen offset:2048 nt
  v_add_f32_dpp v23, v23, v23 quad_perm:[1,0,3,2] row_mask:0xf bank_mask:0xf
  v_add_f32_dpp v22, v22, v22 quad_perm:[2,3,0,1] row_mask:0xf bank_mask:0xf
  v_add_f32_dpp v21, v21, v21 row_half_mirror row_mask:0xf bank_mask:0xf
  ds_write_b32 v36, v21 offset:160
  s_waitcnt vmcnt(5)
  v_mov_b32 v21, 0
  v_dot2c_f32_bf16 v21, v148, v8
  v_dot2c_f32_bf16 v21, v149, v9
  v_dot2c_f32_bf16 v21, v150, v10
  v_dot2c_f32_bf16 v21, v151, v11
  s_and_b32 s38, s32, 31
  s_andn2_b32 s39, s32, 31
  s_lshl_b32 s39, s39, 1
  s_add_u32 s39, s39, s38
  s_add_u32 s39, s39, s33
  s_cmp_ge_u32 s38, s34
  s_cselect_b32 s47, s35, 0
  s_add_u32 s39, s39, s47
  s_cmp_ge_u32 s38, s36
  s_cselect_b32 s47, s37, 0
  s_add_u32 s39, s39, s47
  s_mul_i32 s47, s39, 3072
  s_add_u32 s32, s32, 2
  s_and_b32 s32, s32, 255
  s_waitcnt vmcnt(4)
  buffer_load_dwordx4 v[172:175], v1, s[12:15], s47 offen offset:0 nt
  v_add_f32_dpp v20, v20, v20 quad_perm:[1,0,3,2] row_mask:0xf bank_mask:0xf
  v_add_f32_dpp v23, v23, v23 quad_perm:[2,3,0,1] row_mask:0xf bank_mask:0xf
  v_add_f32_dpp v22, v22, v22 row_half_mirror row_mask:0xf bank_mask:0xf
  ds_write_b32 v36, v22 offset:192
  s_waitcnt vmcnt(5)
  v_mov_b32 v22, 0
  v_dot2c_f32_bf16 v22, v152, v12
  v_dot2c_f32_bf16 v22, v153, v13
  v_dot2c_f32_bf16 v22, v154, v14
  v_dot2c_f32_bf16 v22, v155, v15
  s_cmp_gt_u32 s44, 5
  s_cbranch_scc1 L_th6
  s_waitcnt vmcnt(4)
L_th6:
  buffer_load_dwordx4 v[176:179], v1, s[12:15], s47 offen offset:1024 nt
  v_add_f32_dpp v21, v21, v21 quad_perm:[1,0,3,2] row_mask:0xf bank_mask:0xf
  v_add_f32_dpp v20, v20, v20 quad_perm:[2,3,0,1] row_mask:0xf bank_mask:0xf
  v_add_f32_dpp v23, v23, v23 row_half_mirror row_mask:0xf bank_mask:0xf
  ds_write_b32 v36, v23 offset:224
  s_waitcnt vmcnt(5)
  v_mov_b32 v23, 0
  v_dot2c_f32_bf16 v23, v156, v16
  v_dot2c_f32_bf16 v23, v157, v17
  v_dot2c_f32_bf16 v23, v158, v18
  v_dot2c_f32_bf16 v23, v159, v19
  s_waitcnt vmcnt(4)
  buffer_load_dwordx4 v[180:183], v1, s[12:15], s47 offen offset:2048 nt
  v_add_f32_dpp v22, v22, v22 quad_perm:[1,0,3,2] row_mask:0xf bank_mask:0xf
  v_add_f32_dpp v21, v21, v21 quad_perm:[2,3,0,1] row_mask:0xf bank_mask:0xf
  v_add_f32_dpp v20, v20, v20 row_half_mirror row_mask:0xf bank_mask:0xf
  ds_write_b32 v36, v20 offset:256
  s_waitcnt vmcnt(5)
  v_mov_b32 v20, 0
  v_dot2c_f32_bf16 v20, v160, v8
  v_dot2c_f32_bf16 v20, v161, v9
  v_dot2c_f32_bf16 v20, v162, v10
  v_dot2c_f32_bf16 v20, v163, v11
  s_and_b32 s38, s32, 31
  s_andn2_b32 s39, s32, 31
  s_lshl_b32 s39, s39, 1
  s_add_u32 s39, s39, s38
  s_add_u32 s39, s39, s33
  s_cmp_ge_u32 s38, s34
  s_cselect_b32 s47, s35, 0
  s_add_u32 s39, s39, s47
  s_cmp_ge_u32 s38, s36
  s_cselect_b32 s47, s37, 0
  s_add_u32 s39, s39, s47
  s_mul_i32 s47, s39, 3072
  s_add_u32 s32, s32, 2
  s_and_b32 s32, s32, 255
  s_cmp_gt_u32 s44, 6
  s_cbranch_scc1 L_th7
  s_waitcnt vmcnt(4)
L_th7:
  buffer_load_dwordx4 v[184:187], v1, s[12:15], s47 offen offset:0 nt
  v_add_f32_dpp v23, v23, v23 quad_perm:[1,0,3,2] row_mask:0xf bank_mask:0xf
  v_add_f32_dpp v22, v22, v22 quad_perm:[2,3,0,1] row_mask:0xf bank_mask:0xf
  v_add_f32_dpp v21, v21, v21 row_half_mirror row_mask:0xf bank_mask:0xf
  ds_write_b32 v36, v21 offset:288
  s_waitcnt vmcnt(5)
  v_mov_b32 v21, 0
  v_dot2c_f32_bf16 v21, v164, v12
  v_dot2c_f32_bf16 v21, v165, v13
  v_dot2c_f32_bf16 v21, v166, v14
  v_dot2c_f32_bf16 v21, v167, v15
  s_waitcnt vmcnt(4)
  buffer_load_dwordx4 v[188:191], v1, s[12:15], s47 offen offset:1024 nt
  v_add_f32_dpp v20, v20, v20 quad_perm:[1,0,3,2] row_mask:0xf bank_mask:0xf
  v_add_f32_dpp v23, v23, v23 quad_perm:[2,3,0,1] row_mask:0xf bank_mask:0xf
  v_add_f32_dpp v22, v22, v22 row_half_mirror row_mask:0xf bank_mask:0xf
  ds_write_b32 v36, v22 offset:320
  s_waitcnt vmcnt(5)
  v_mov_b32 v22, 0
  v_dot2c_f32_bf16 v22, v168, v16
  v_dot2c_f32_bf16 v22, v169, v17
  v_dot2c_f32_bf16 v22, v170, v18
  v_dot2c_f32_bf16 v22, v171, v19
  s_cmp_gt_u32 s44, 7
  s_cbranch_scc1 L_th8
  s_waitcnt vmcnt(4)
L_th8:
  buffer_load_dwordx4 v[192:195], v1, s[12:15], s47 offen offset:2048 nt
  v_add_f32_dpp v21, v21, v21 quad_perm:[1,0,3,2] row_mask:0xf bank_mask:0xf
  v_add_f32_dpp v20, v20, v20 quad_perm:[2,3,0,1] row_mask:0xf bank_mask:0xf
  v_add_f32_dpp v23, v23, v23 row_half_mirror row_mask:0xf bank_mask:0xf
  ds_write_b32 v36, v23 offset:352
  s_waitcnt vmcnt(5)
  v_mov_b32 v23, 0
  v_dot2c_f32_bf16 v23, v172, v8
  v_dot2c_f32_bf16 v23, v173, v9
  v_dot2c_f32_bf16 v23, v174, v10
  v_dot2c_f32_bf16 v23, v175, v11
  s_and_b32 s38, s32, 31
  s_andn2_b32 s39, s32, 31
  s_lshl_b32 s39, s39, 1
  s_add_u32 s39, s39, s38
  s_add_u32 s39, s39, s33
  s_cmp_ge_u32 s38, s34
  s_cselect_b32 s47, s35, 0
  s_add_u32 s39, s39, s47
  s_cmp_ge_u32 s38, s36
  s_cselect_b32 s47, s37, 0
  s_add_u32 s39, s39, s47
  s_mul_i32 s47, s39, 3072
  s_add_u32 s32, s32, 2
  s_and_b32 s32, s32, 255
  s_waitcnt vmcnt(4)
  buffer_load_dwordx4 v[196:199], v1, s[12:15], s47 offen offset:0 nt
  v_add_f32_dpp v22, v22, v22 quad_perm:[1,0,3,2] row_mask:0xf bank_mask:0xf
  v_add_f32_dpp v21, v21, v21 quad_perm:[2,3,0,1] row_mask:0xf bank_mask:0xf
  v_add_f32_dpp v20, v20, v20 row_half_mirror row_mask:0xf bank_mask:0xf
  ds_write_b32 v36, v20 offset:384
  s_waitcnt vmcnt(5)
  v_mov_b32 v20, 0
  v_dot2c_f32_bf16 v20, v176, v12
  v_dot2c_f32_bf16 v20, v177, v13
  v_dot2c_f32_bf16 v20, v178, v14
  v_dot2c_f32_bf16 v20, v179, v15
  s_cmp_gt_u32 s44, 8
  s_cbranch_scc1 L_th9
  s_waitcnt vmcnt(4)
L_th9:
  buffer_load_dwordx4 v[200:203], v1, s[12:15], s47 offen offset:1024 nt
  v_add_f32_dpp v23, v23, v23 quad_perm:[1,0,3,2] row_mask:0xf bank_mask:0xf
  v_add_f32_dpp v22, v22, v22 quad_perm:[2,3,0,1] row_mask:0xf bank_mask:0xf
  v_add_f32_dpp v21, v21, v21 row_half_mirror row_mask:0xf bank_mask:0xf
  ds_write_b32 v36, v21 offset:416
  s_waitcnt vmcnt(5)
  v_mov_b32 v21, 0
  v_dot2c_f32_bf16 v21, v180, v16
  v_dot2c_f32_bf16 v21, v181, v17
  v_dot2c_f32_bf16 v21, v182, v18
  v_dot2c_f32_bf16 v21, v183, v19
  s_waitcnt vmcnt(4)
  buffer_load_dwordx4 v[204:207], v1, s[12:15], s47 offen offset:2048 nt
  v_add_f32_dpp v20, v20, v20 quad_perm:[1,0,3,2] row_mask:0xf bank_mask:0xf
  v_add_f32_dpp v23, v23, v23 quad_perm:[2,3,0,1] row_mask:0xf bank_mask:0xf
  v_add_f32_dpp v22, v22, v22 row_half_mirror row_mask:0xf bank_mask:0xf
  ds_write_b32 v36, v22 offset:448
  s_waitcnt vmcnt(5)
  v_mov_b32 v22, 0
  v_dot2c_f32_bf16 v22, v184, v8
  v_dot2c_f32_bf16 v22, v185, v9
  v_dot2c_f32_bf16 v22, v186, v10
  v_dot2c_f32_bf16 v22, v187, v11
  s_and_b32 s38, s32, 31
  s_andn2_b32 s39, s32, 31
  s_lshl_b32 s39, s39, 1
  s_add_u32 s39, s39, s38
  s_add_u32 s39, s39, s33
  s_cmp_ge_u32 s38, s34
  s_cselect_b32 s47, s35, 0
  s_add_u32 s39, s39, s47
  s_cmp_ge_u32 s38, s36
  s_cselect_b32 s47, s37, 0
  s_add_u32 s39, s39, s47
  s_mul_i32 s47, s39, 3072
  s_add_u32 s32, s32, 2
  s_and_b32 s32, s32, 255
  s_cmp_gt_u32 s44, 9
  s_cbranch_scc1 L_th10
  s_waitcnt vmcnt(4)
L_th10:
  buffer_load_dwordx4 v[112:115], v1, s[12:15], s47 offen offset:0 nt
  v_add_f32_dpp v21, v21, v21 quad_perm:[1,0,3,2] row_mask:0xf bank_mask:0xf
  v_add_f32_dpp v20, v20, v20 quad_perm:[2,3,0,1] row_mask:0xf bank_mask:0xf
  v_add_f32_dpp v23, v23, v23 row_half_mirror row_mask:0xf bank_mask:0xf
  ds_write_b32 v36, v23 offset:480
  s_waitcnt vmcnt(5)
  v_mov_b32 v23, 0
  v_dot2c_f32_bf16 v23, v188, v12
  v_dot2c_f32_bf16 v23, v189, v13
  v_dot2c_f32_bf16 v23, v190, v14
  v_dot2c_f32_bf16 v23, v191, v15
  s_waitcnt vmcnt(4)
  buffer_load_dwordx4 v[116:119], v1, s[12:15], s47 offen offset:1024 nt
  v_add_f32_dpp v22, v22, v22 quad_perm:[1,0,3,2] row_mask:0xf bank_mask:0xf
  v_add_f32_dpp v21, v21, v21 quad_perm:[2,3,0,1] row_mask:0xf bank_mask:0xf
  v_add_f32_dpp v20, v20, v20 row_half_mirror row_mask:0xf bank_mask:0xf
  ds_write_b32 v36, v20 offset:512
  s_waitcnt vmcnt(5)
  v_mov_b32 v20, 0
  v_dot2c_f32_bf16 v20, v192, v16
  v_dot2c_f32_bf16 v20, v193, v17
  v_dot2c_f32_bf16 v20, v194, v18
  v_dot2c_f32_bf16 v20, v195, v19
  s_cmp_gt_u32 s44, 10
  s_cbranch_scc1 L_th11
  s_waitcnt vmcnt(4)
L_th11:
  buffer_load_dwordx4 v[120:123], v1, s[12:15], s47 offen offset:2048 nt
  v_add_f32_dpp v23, v23, v23 quad_perm:[1,0,3,2] row_mask:0xf bank_mask:0xf
  v_add_f32_dpp v22, v22, v22 quad_perm:[2,3,0,1] row_mask:0xf bank_mask:0xf
  v_add_f32_dpp v21, v21, v21 row_half_mirror row_mask:0xf bank_mask:0xf
  ds_write_b32 v36, v21 offset:544
  s_waitcnt vmcnt(5)
  v_mov_b32 v21, 0
  v_dot2c_f32_bf16 v21, v196, v8
  v_dot2c_f32_bf16 v21, v197, v9
  v_dot2c_f32_bf16 v21, v198, v10
  v_dot2c_f32_bf16 v21, v199, v11
  s_and_b32 s38, s32, 31
  s_andn2_b32 s39, s32, 31
  s_lshl_b32 s39, s39, 1
  s_add_u32 s39, s39, s38
  s_add_u32 s39, s39, s33
  s_cmp_ge_u32 s38, s34
  s_cselect_b32 s47, s35, 0
  s_add_u32 s39, s39, s47
  s_cmp_ge_u32 s38, s36
  s_cselect_b32 s47, s37, 0
  s_add_u32 s39, s39, s47
  s_mul_i32 s47, s39, 3072
  s_add_u32 s32, s32, 2
  s_and_b32 s32, s32, 255
  s_waitcnt vmcnt(4)
  buffer_load_dwordx4 v[124:127], v1, s[12:15], s47 offen offset:0 nt
  v_add_f32_dpp v20, v20, v20 quad_perm:[1,0,3,2] row_mask:0xf bank_mask:0xf
  v_add_f32_dpp v23, v23, v23 quad_perm:[2,3,0,1] row_mask:0xf bank_mask:0xf
  v_add_f32_dpp v22, v22, v22 row_half_mirror row_mask:0xf bank_mask:0xf
  ds_write_b32 v36, v22 offset:576
  s_waitcnt vmcnt(5)
  v_mov_b32 v22, 0
  v_dot2c_f32_bf16 v22, v200, v12
  v_dot2c_f32_bf16 v22, v201, v13
  v_dot2c_f32_bf16 v22, v202, v14
  v_dot2c_f32_bf16 v22, v203, v15
  s_cmp_gt_u32 s44, 11
  s_cbranch_scc1 L_th12
  s_waitcnt vmcnt(4)
L_th12:
  buffer_load_dwordx4 v[128:131], v1, s[12:15], s47 offen offset:1024 nt
  v_add_f32_dpp v21, v21, v21 quad_perm:[1,0,3,2] row_mask:0xf bank_mask:0xf
  v_add_f32_dpp v20, v20, v20 quad_perm:[2,3,0,1] row_mask:0xf bank_mask:0xf
  v_add_f32_dpp v23, v23, v23 row_half_mirror row_mask:0xf bank_mask:0xf
  ds_write_b32 v36, v23 offset:608
  s_waitcnt vmcnt(5)
  v_mov_b32 v23, 0
  v_dot2c_f32_bf16 v23, v204, v16
  v_dot2c_f32_bf16 v23, v205, v17
  v_dot2c_f32_bf16 v23, v206, v18
  v_dot2c_f32_bf16 v23, v207, v19
  s_waitcnt vmcnt(4)
  buffer_load_dwordx4 v[132:135], v1, s[12:15], s47 offen offset:2048 nt
  v_add_f32_dpp v22, v22, v22 quad_perm:[1,0,3,2] row_mask:0xf bank_mask:0xf
  v_add_f32_dpp v21, v21, v21 quad_perm:[2,3,0,1] row_mask:0xf bank_mask:0xf
  v_add_f32_dpp v20, v20, v20 row_half_mirror row_mask:0xf bank_mask:0xf
  ds_write_b32 v36, v20 offset:640
  s_mov_b32 s30, 14
L_loopK:
  s_waitcnt vmcnt(5)
  v_mov_b32 v20, 0
  v_dot2c_f32_bf16 v20, v112, v8
  v_dot2c_f32_bf16 v20, v113, v9
  v_dot2c_f32_bf16 v20, v114, v10
  v_dot2c_f32_bf16 v20, v115, v11
  s_and_b32 s38, s32, 31
  s_andn2_b32 s39, s32, 31
  s_lshl_b32 s39, s39, 1
  s_add_u32 s39, s39, s38
  s_add_u32 s39, s39, s33
  s_cmp_ge_u32 s38, s34
  s_cselect_b32 s47, s35, 0
  s_add_u32 s39, s39, s47
  s_cmp_ge_u32 s38, s36
  s_cselect_b32 s47, s37, 0
  s_add_u32 s39, s39, s47
  s_mul_i32 s47, s39, 3072
  s_add_u32 s32, s32, 2
  s_and_b32 s32, s32, 255
  s_cmp_gt_u32 s44, 0
  s_cbranch_scc1 L_th13
  s_waitcnt vmcnt(4)
L_th13:
  buffer_load_dwordx4 v[136:139], v1, s[12:15], s47 offen offset:0 nt
  v_add_f32_dpp v23, v23, v23 quad_perm:[1,0,3,2] row_mask:0xf bank_mask:0xf
  v_add_f32_dpp v22, v22, v22 quad_perm:[2,3,0,1] row_mask:0xf bank_mask:0xf
  v_add_f32_dpp v21, v21, v21 row_half_mirror row_mask:0xf bank_mask:0xf
  ds_write_b32 v36, v21 offset:672
  s_waitcnt vmcnt(5)
  v_mov_b32 v21, 0
  v_dot2c_f32_bf16 v21, v116, v12
  v_dot2c_f32_bf16 v21, v117, v13
  v_dot2c_f32_bf16 v21, v118, v14
  v_dot2c_f32_bf16 v21, v119, v15
  s_waitcnt vmcnt(4)
  buffer_load_dwordx4 v[140:143], v1, s[12:15], s47 offen offset:1024 nt
  v_add_f32_dpp v20, v20, v20 quad_perm:[1,0,3,2] row_mask:0xf bank_mask:0xf
  v_add_f32_dpp v23, v23, v23 quad_perm:[2,3,0,1] row_mask:0xf bank_mask:0xf
  v_add_f32_dpp v22, v22, v22 row_half_mirror row_mask:0xf bank_mask:0xf
  ds_write_b32 v36, v22 offset:704
  s_waitcnt vmcnt(5)
  v_mov_b32 v22, 0
  v_dot2c_f32_bf16 v22, v120, v16
  v_dot2c_f32_bf16 v22, v121, v17
  v_dot2c_f32_bf16 v22, v122, v18
  v_dot2c_f32_bf16 v22, v123, v19
  s_cmp_gt_u32 s44, 1
  s_cbranch_scc1 L_th14
  s_waitcnt vmcnt(4)
L_th14:
  buffer_load_dwordx4 v[144:147], v1, s[12:15], s47 offen offset:2048 nt
  v_add_f32_dpp v21, v21, v21 quad_perm:[1,0,3,2] row_mask:0xf bank_mask:0xf
  v_add_f32_dpp v20, v20, v20 quad_perm:[2,3,0,1] row_mask:0xf bank_mask:0xf
  v_add_f32_dpp v23, v23, v23 row_half_mirror row_mask:0xf bank_mask:0xf
  ds_write_b32 v36, v23 offset:736
  v_add_u32 v36, 768, v36
  s_waitcnt vmcnt(5)
  v_mov_b32 v23, 0
  v_dot2c_f32_bf16 v23, v124, v8
  v_dot2c_f32_bf16 v23, v125, v9
  v_dot2c_f32_bf16 v23, v126, v10
  v_dot2c_f32_bf16 v23, v127, v11
  s_and_b32 s38, s32, 31
  s_andn2_b32 s39, s32, 31
  s_lshl_b32 s39, s39, 1
  s_add_u32 s39, s39, s38
  s_add_u32 s39, s39, s33
  s_cmp_ge_u32 s38, s34
  s_cselect_b32 s47, s35, 0
  s_add_u32 s39, s39, s47
  s_cmp_ge_u32 s38, s36
  s_cselect_b32 s47, s37, 0
  s_add_u32 s39, s39, s47
  s_mul_i32 s47, s39, 3072
  s_add_u32 s32, s32, 2
  s_and_b32 s32, s32, 255
  s_waitcnt vmcnt(4)
  buffer_load_dwordx4 v[148:151], v1, s[12:15], s47 offen offset:0 nt
  v_add_f32_dpp v22, v22, v22 quad_perm:[1,0,3,2] row_mask:0xf bank_mask:0xf
  v_add_f32_dpp v21, v21, v21 quad_perm:[2,3,0,1] row_mask:0xf bank_mask:0xf
  v_add_f32_dpp v20, v20, v20 row_half_mirror row_mask:0xf bank_mask:0xf
  ds_write_b32 v36, v20 offset:0
  s_waitcnt vmcnt(5)
  v_mov_b32 v20, 0
  v_dot2c_f32_bf16 v20, v128, v12
  v_dot2c_f32_bf16 v20, v129, v13
  v_dot2c_f32_bf16 v20, v130, v14
  v_dot2c_f32_bf16 v20, v131, v15
  s_cmp_gt_u32 s44, 2
  s_cbranch_scc1 L_th15
  s_waitcnt vmcnt(4)
L_th15:
  buffer_load_dwordx4 v[152:155], v1, s[12:15], s47 offen offset:1024 nt
  v_add_f32_dpp v23, v23, v23 quad_perm:[1,0,3,2] row_mask:0xf bank_mask:0xf
  v_add_f32_dpp v22, v22, v22 quad_perm:[2,3,0,1] row_mask:0xf bank_mask:0xf
  v_add_f32_dpp v21, v21, v21 row_half_mirror row_mask:0xf bank_mask:0xf
  ds_write_b32 v36, v21 offset:32
  s_waitcnt vmcnt(5)
  v_mov_b32 v21, 0
  v_dot2c_f32_bf16 v21, v132, v16
  v_dot2c_f32_bf16 v21, v133, v17
  v_dot2c_f32_bf16 v21, v134, v18
  v_dot2c_f32_bf16 v21, v135, v19
  s_waitcnt vmcnt(4)
  buffer_load_dwordx4 v[156:159], v1, s[12:15], s47 offen offset:2048 nt
  v_add_f32_dpp v20, v20, v20 quad_perm:[1,0,3,2] row_mask:0xf bank_mask:0xf
  v_add_f32_dpp v23, v23, v23 quad_perm:[2,3,0,1] row_mask:0xf bank_mask:0xf
  v_add_f32_dpp v22, v22, v22 row_half_mirror row_mask:0xf bank_mask:0xf
  ds_write_b32 v36, v22 offset:64
  s_waitcnt vmcnt(5)
  v_mov_b32 v22, 0
  v_dot2c_f32_bf16 v22, v136, v8
  v_dot2c_f32_bf16 v22, v137, v9
  v_dot2c_f32_bf16 v22, v138, v10
  v_dot2c_f32_bf16 v22, v139, v11
  s_and_b32 s38, s32, 31
  s_andn2_b32 s39, s32, 31
  s_lshl_b32 s39, s39, 1
  s_add_u32 s39, s39, s38
  s_add_u32 s39, s39, s33
  s_cmp_ge_u32 s38, s34
  s_cselect_b32 s47, s35, 0
  s_add_u32 s39, s39, s47
  s_cmp_ge_u32 s38, s36
  s_cselect_b32 s47, s37, 0
  s_add_u32 s39, s39, s47
  s_mul_i32 s47, s39, 3072
  s_add_u32 s32, s32, 2
  s_and_b32 s32, s32, 255
  s_cmp_gt_u32 s44, 3
  s_cbranch_scc1 L_th16
  s_waitcnt vmcnt(4)
L_th16:
  buffer_load_dwordx4 v[160:163], v1, s[12:15], s47 offen offset:0 nt
  v_add_f32_dpp v21, v21, v21 quad_perm:[1,0,3,2] row_mask:0xf bank_mask:0xf
  v_add_f32_dpp v20, v20, v20 quad_perm:[2,3,0,1] row_mask:0xf bank_mask:0xf
  v_add_f32_dpp v23, v23, v23 row_half_mirror row_mask:0xf bank_mask:0xf
  ds_write_b32 v36, v23 offset:96
  s_waitcnt vmcnt(5)
  v_mov_b32 v23, 0
  v_dot2c_f32_bf16 v23, v140, v12
  v_dot2c_f32_bf16 v23, v141, v13
  v_dot2c_f32_bf16 v23, v142, v14
  v_dot2c_f32_bf16 v23, v143, v15
  s_waitcnt vmcnt(4)
  buffer_load_dwordx4 v[164:167], v1, s[12:15], s47 offen offset:1024 nt
  v_add_f32_dpp v22, v22, v22 quad_perm:[1,0,3,2] row_mask:0xf bank_mask:0xf
  v_add_f32_dpp v21, v21, v21 quad_perm:[2,3,0,1] row_mask:0xf bank_mask:0xf
  v_add_f32_dpp v20, v20, v20 row_half_mirror row_mask:0xf bank_mask:0xf
  ds_write_b32 v36, v20 offset:128
  s_waitcnt vmcnt(5)
  v_mov_b32 v20, 0
  v_dot2c_f32_bf16 v20, v144, v16
  v_dot2c_f32_bf16 v20, v145, v17
  v_dot2c_f32_bf16 v20, v146, v18
  v_dot2c_f32_bf16 v20, v147, v19
  s_cmp_gt_u32 s44, 4
  s_cbranch_scc1 L_th17
  s_waitcnt vmcnt(4)
L_th17:
  buffer_load_dwordx4 v[168:171], v1, s[12:15], s47 offen offset:2048 nt
  s_add_u32 s88, s88, 1
  v_mov_b32 v210, s88
  buffer_store_byte v210, v208, s[84:87], 0 offen
  buffer_load_ubyte v211, v209, s[84:87], 0 offen nt
  s_and_b32 s93, s88, 1
  s_cmp_eq_u32 s93, 0
  s_cselect_b32 s93, 0, 0x1000
  v_add_u32 v215, s93, v212
  buffer_load_dword v213, v215, s[84:87], 0 offen sc1
  v_add_f32_dpp v23, v23, v23 quad_perm:[1,0,3,2] row_mask:0xf bank_mask:0xf
  v_add_f32_dpp v22, v22, v22 quad_perm:[2,3,0,1] row_mask:0xf bank_mask:0xf
  v_add_f32_dpp v21, v21, v21 row_half_mirror row_mask:0xf bank_mask:0xf
  ds_write_b32 v36, v21 offset:160
  s_waitcnt vmcnt(8)
  v_mov_b32 v21, 0
  v_dot2c_f32_bf16 v21, v148, v8
  v_dot2c_f32_bf16 v21, v149, v9
  v_dot2c_f32_bf16 v21, v150, v10
  v_dot2c_f32_bf16 v21, v151, v11
  s_and_b32 s38, s32, 31
  s_andn2_b32 s39, s32, 31
  s_lshl_b32 s39, s39, 1
  s_add_u32 s39, s39, s38
  s_add_u32 s39, s39, s33
  s_cmp_ge_u32 s38, s34
  s_cselect_b32 s47, s35, 0
  s_add_u32 s39, s39, s47
  s_cmp_ge_u32 s38, s36
  s_cselect_b32 s47, s37, 0
  s_add_u32 s39, s39, s47
  s_mul_i32 s47, s39, 3072
  s_add_u32 s32, s32, 2
  s_and_b32 s32, s32, 255
  s_waitcnt vmcnt(7)
  buffer_load_dwordx4 v[172:175], v1, s[12:15], s47 offen offset:0 nt
  v_add_f32_dpp v20, v20, v20 quad_perm:[1,0,3,2] row_mask:0xf bank_mask:0xf
  v_add_f32_dpp v23, v23, v23 quad_perm:[2,3,0,1] row_mask:0xf bank_mask:0xf
  v_add_f32_dpp v22, v22, v22 row_half_mirror row_mask:0xf bank_mask:0xf
  ds_write_b32 v36, v22 offset:192
  s_waitcnt vmcnt(8)
  v_mov_b32 v22, 0
  v_dot2c_f32_bf16 v22, v152, v12
  v_dot2c_f32_bf16 v22, v153, v13
  v_dot2c_f32_bf16 v22, v154, v14
  v_dot2c_f32_bf16 v22, v155, v15
  s_cmp_gt_u32 s44, 5
  s_cbranch_scc1 L_th18
  s_waitcnt vmcnt(7)
L_th18:
  buffer_load_dwordx4 v[176:179], v1, s[12:15], s47 offen offset:1024 nt
  v_add_f32_dpp v21, v21, v21 quad_perm:[1,0,3,2] row_mask:0xf bank_mask:0xf
  v_add_f32_dpp v20, v20, v20 quad_perm:[2,3,0,1] row_mask:0xf bank_mask:0xf
  v_add_f32_dpp v23, v23, v23 row_half_mirror row_mask:0xf bank_mask:0xf
  ds_write_b32 v36, v23 offset:224
  s_waitcnt vmcnt(8)
  v_mov_b32 v23, 0
  v_dot2c_f32_bf16 v23, v156, v16
  v_dot2c_f32_bf16 v23, v157, v17
  v_dot2c_f32_bf16 v23, v158, v18
  v_dot2c_f32_bf16 v23, v159, v19
  s_waitcnt vmcnt(7)
  buffer_load_dwordx4 v[180:183], v1, s[12:15], s47 offen offset:2048 nt
  v_add_f32_dpp v22, v22, v22 quad_perm:[1,0,3,2] row_mask:0xf bank_mask:0xf
  v_add_f32_dpp v21, v21, v21 quad_perm:[2,3,0,1] row_mask:0xf bank_mask:0xf
  v_add_f32_dpp v20, v20, v20 row_half_mirror row_mask:0xf bank_mask:0xf
  ds_write_b32 v36, v20 offset:256
  s_waitcnt vmcnt(8)
  v_mov_b32 v20, 0
  v_dot2c_f32_bf16 v20, v160, v8
  v_dot2c_f32_bf16 v20, v161, v9
  v_dot2c_f32_bf16 v20, v162, v10
  v_dot2c_f32_bf16 v20, v163, v11
  s_and_b32 s38, s32, 31
  s_andn2_b32 s39, s32, 31
  s_lshl_b32 s39, s39, 1
  s_add_u32 s39, s39, s38
  s_add_u32 s39, s39, s33
  s_cmp_ge_u32 s38, s34
  s_cselect_b32 s47, s35, 0
  s_add_u32 s39, s39, s47
  s_cmp_ge_u32 s38, s36
  s_cselect_b32 s47, s37, 0
  s_add_u32 s39, s39, s47
  s_mul_i32 s47, s39, 3072
  s_add_u32 s32, s32, 2
  s_and_b32 s32, s32, 255
  s_cmp_gt_u32 s44, 6
  s_cbranch_scc1 L_th19
  s_waitcnt vmcnt(7)
L_th19:
  buffer_load_dwordx4 v[184:187], v1, s[12:15], s47 offen offset:0 nt
  v_add_f32_dpp v23, v23, v23 quad_perm:[1,0,3,2] row_mask:0xf bank_mask:0xf
  v_add_f32_dpp v22, v22, v22 quad_perm:[2,3,0,1] row_mask:0xf bank_mask:0xf
  v_add_f32_dpp v21, v21, v21 row_half_mirror row_mask:0xf bank_mask:0xf
  ds_write_b32 v36, v21 offset:288
  s_waitcnt vmcnt(8)
  v_mov_b32 v21, 0
  v_dot2c_f32_bf16 v21, v164, v12
  v_dot2c_f32_bf16 v21, v165, v13
  v_dot2c_f32_bf16 v21, v166, v14
  v_dot2c_f32_bf16 v21, v167, v15
  s_waitcnt vmcnt(7)
  buffer_load_dwordx4 v[188:191], v1, s[12:15], s47 offen offset:1024 nt
  v_add_f32_dpp v20, v20, v20 quad_perm:[1,0,3,2] row_mask:0xf bank_mask:0xf
  v_add_f32_dpp v23, v23, v23 quad_perm:[2,3,0,1] row_mask:0xf bank_mask:0xf
  v_add_f32_dpp v22, v22, v22 row_half_mirror row_mask:0xf bank_mask:0xf
  ds_write_b32 v36, v22 offset:320
  s_waitcnt vmcnt(8)
  v_mov_b32 v22, 0
  v_dot2c_f32_bf16 v22, v168, v16
  v_dot2c_f32_bf16 v22, v169, v17
  v_dot2c_f32_bf16 v22, v170, v18
  v_dot2c_f32_bf16 v22, v171, v19
  s_cmp_gt_u32 s44, 7
  s_cbranch_scc1 L_th20
  s_waitcnt vmcnt(4)
L_th20:
  buffer_load_dwordx4 v[192:195], v1, s[12:15], s47 offen offset:2048 nt
  v_add_f32_dpp v21, v21, v21 quad_perm:[1,0,3,2] row_mask:0xf bank_mask:0xf
  v_add_f32_dpp v20, v20, v20 quad_perm:[2,3,0,1] row_mask:0xf bank_mask:0xf
  v_add_f32_dpp v23, v23, v23 row_half_mirror row_mask:0xf bank_mask:0xf
  ds_write_b32 v36, v23 offset:352
  s_waitcnt vmcnt(5)
  v_mov_b32 v23, 0
  v_dot2c_f32_bf16 v23, v172, v8
  v_dot2c_f32_bf16 v23, v173, v9
  v_dot2c_f32_bf16 v23, v174, v10
  v_dot2c_f32_bf16 v23, v175, v11
  s_and_b32 s38, s32, 31
  s_andn2_b32 s39, s32, 31
  s_lshl_b32 s39, s39, 1
  s_add_u32 s39, s39, s38
  s_add_u32 s39, s39, s33
  s_cmp_ge_u32 s38, s34
  s_cselect_b32 s47, s35, 0
  s_add_u32 s39, s39, s47
  s_cmp_ge_u32 s38, s36
  s_cselect_b32 s47, s37, 0
  s_add_u32 s39, s39, s47
  s_mul_i32 s47, s39, 3072
  s_add_u32 s32, s32, 2
  s_and_b32 s32, s32, 255
  s_waitcnt vmcnt(4)
  buffer_load_dwordx4 v[196:199], v1, s[12:15], s47 offen offset:0 nt
  v_add_f32_dpp v22, v22, v22 quad_perm:[1,0,3,2] row_mask:0xf bank_mask:0xf
  v_add_f32_dpp v21, v21, v21 quad_perm:[2,3,0,1] row_mask:0xf bank_mask:0xf
  v_add_f32_dpp v20, v20, v20 row_half_mirror row_mask:0xf bank_mask:0xf
  ds_write_b32 v36, v20 offset:384
  s_waitcnt vmcnt(5)
  v_mov_b32 v20, 0
  v_dot2c_f32_bf16 v20, v176, v12
  v_dot2c_f32_bf16 v20, v177, v13
  v_dot2c_f32_bf16 v20, v178, v14
  v_dot2c_f32_bf16 v20, v179, v15
  s_cmp_gt_u32 s44, 8
  s_cbranch_scc1 L_th21
  s_waitcnt vmcnt(4)
L_th21:
  buffer_load_dwordx4 v[200:203], v1, s[12:15], s47 offen offset:1024 nt
  v_cmp_ge_u32 vcc, v211, v210
  s_nop 1
  s_bcnt1_i32_b64 s90, vcc
  s_sub_i32 s90, s90, 10
  s_max_i32 s90, s90, 0
  s_lshr_b32 s90, s90, 1
  s_cmp_lg_u32 s93, 0
  s_cbranch_scc1 L_ng22
  v_sad_u8 v213, v213, 0, 0
  s_nop 1
  v_add_u32_dpp v213, v213, v213 quad_perm:[1,0,3,2] row_mask:0xf bank_mask:0xf
  s_nop 1
  v_add_u32_dpp v213, v213, v213 quad_perm:[2,3,0,1] row_mask:0xf bank_mask:0xf
  s_nop 1
  v_add_u32_dpp v213, v213, v213 row_half_mirror row_mask:0xf bank_mask:0xf
  s_nop 1
  v_readlane_b32 s94, v213, s92
  v_add_u32_dpp v213, v213, v213 row_mirror row_mask:0xf bank_mask:0xf
  s_nop 0
  v_mov_b32 v214, v213
  s_nop 1
  v_permlane16_swap_b32 v213, v214
  s_nop 1
  v_add_u32 v213, v213, v214
  s_nop 0
  v_mov_b32 v214, v213
  s_nop 1
  v_permlane32_swap_b32 v213, v214
  s_nop 1
  v_add_u32 v213, v213, v214
  s_nop 0
  v_readfirstlane_b32 s91, v213
  s_lshr_b32 s91, s91, 3
  s_sub_i32 s91, s91, s94
  s_max_i32 s91, s91, 0
  s_mul_i32 s91, s91, 3
  s_lshr_b32 s91, s91, 2
  s_min_u32 s91, s91, 8
L_ng22:
  s_add_i32 s90, s90, s91
  s_add_i32 s44, s90, s89
  v_add_f32_dpp v23, v23, v23 quad_perm:[1,0,3,2] row_mask:0xf bank_mask:0xf
  v_add_f32_dpp v22, v22, v22 quad_perm:[2,3,0,1] row_mask:0xf bank_mask:0xf
  v_add_f32_dpp v21, v21, v21 row_half_mirror row_mask:0xf bank_mask:0xf
  ds_write_b32 v36, v21 offset:416
  s_waitcnt vmcnt(5)
  v_mov_b32 v21, 0
  v_dot2c_f32_bf16 v21, v180, v16
  v_dot2c_f32_bf16 v21, v181, v17
  v_dot2c_f32_bf16 v21, v182, v18
  v_dot2c_f32_bf16 v21, v183, v19
  s_waitcnt vmcnt(4)
  buffer_load_dwordx4 v[204:207], v1, s[12:15], s47 offen offset:2048 nt
  v_add_f32_dpp v20, v20, v20 quad_perm:[1,0,3,2] row_mask:0xf bank_mask:0xf
  v_add_f32_dpp v23, v23, v23 quad_perm:[2,3,0,1] row_mask:0xf bank_mask:0xf
  v_add_f32_dpp v22, v22, v22 row_half_mirror row_mask:0xf bank_mask:0xf
  ds_write_b32 v36, v22 offset:448
  s_waitcnt vmcnt(5)
  v_mov_b32 v22, 0
  v_dot2c_f32_bf16 v22, v184, v8
  v_dot2c_f32_bf16 v22, v185, v9
  v_dot2c_f32_bf16 v22, v186, v10
  v_dot2c_f32_bf16 v22, v187, v11
  s_and_b32 s38, s32, 31
  s_andn2_b32 s39, s32, 31
  s_lshl_b32 s39, s39, 1
  s_add_u32 s39, s39, s38
  s_add_u32 s39, s39, s33
  s_cmp_ge_u32 s38, s34
  s_cselect_b32 s47, s35, 0
  s_add_u32 s39, s39, s47
  s_cmp_ge_u32 s38, s36
  s_cselect_b32 s47, s37, 0
  s_add_u32 s39, s39, s47
  s_mul_i32 s47, s39, 3072
  s_add_u32 s32, s32, 2
  s_and_b32 s32, s32, 255
  s_cmp_gt_u32 s44, 9
  s_cbranch_scc1 L_th23
  s_waitcnt vmcnt(4)
L_th23:
  buffer_load_dwordx4 v[112:115], v1, s[12:15], s47 offen offset:0 nt
  v_add_f32_dpp v21, v21, v21 quad_perm:[1,0,3,2] row_mask:0xf bank_mask:0xf
  v_add_f32_dpp v20, v20, v20 quad_perm:[2,3,0,1] row_mask:0xf bank_mask:0xf
  v_add_f32_dpp v23, v23, v23 row_half_mirror row_mask:0xf bank_mask:0xf
  ds_write_b32 v36, v23 offset:480
  s_waitcnt vmcnt(5)
  v_mov_b32 v23, 0
  v_dot2c_f32_bf16 v23, v188, v12
  v_dot2c_f32_bf16 v23, v189, v13
  v_dot2c_f32_bf16 v23, v190, v14
  v_dot2c_f32_bf16 v23, v191, v15
  s_waitcnt vmcnt(4)
  buffer_load_dwordx4 v[116:119], v1, s[12:15], s47 offen offset:1024 nt
  v_add_f32_dpp v22, v22, v22 quad_perm:[1,0,3,2] row_mask:0xf bank_mask:0xf
  v_add_f32_dpp v21, v21, v21 quad_perm:[2,3,0,1] row_mask:0xf bank_mask:0xf
  v_add_f32_dpp v20, v20, v20 row_half_mirror row_mask:0xf bank_mask:0xf
  ds_write_b32 v36, v20 offset:512
  s_waitcnt vmcnt(5)
  v_mov_b32 v20, 0
  v_dot2c_f32_bf16 v20, v192, v16
  v_dot2c_f32_bf16 v20, v193, v17
  v_dot2c_f32_bf16 v20, v194, v18
  v_dot2c_f32_bf16 v20, v195, v19
  s_cmp_gt_u32 s44, 10
  s_cbranch_scc1 L_th24
  s_waitcnt vmcnt(4)
L_th24:
  buffer_load_dwordx4 v[120:123], v1, s[12:15], s47 offen offset:2048 nt
  v_add_f32_dpp v23, v23, v23 quad_perm:[1,0,3,2] row_mask:0xf bank_mask:0xf
  v_add_f32_dpp v22, v22, v22 quad_perm:[2,3,0,1] row_mask:0xf bank_mask:0xf
  v_add_f32_dpp v21, v21, v21 row_half_mirror row_mask:0xf bank_mask:0xf
  ds_write_b32 v36, v21 offset:544
  s_waitcnt vmcnt(5)
  v_mov_b32 v21, 0
  v_dot2c_f32_bf16 v21, v196, v8
  v_dot2c_f32_bf16 v21, v197, v9
  v_dot2c_f32_bf16 v21, v198, v10
  v_dot2c_f32_bf16 v21, v199, v11
  s_and_b32 s38, s32, 31
  s_andn2_b32 s39, s32, 31
  s_lshl_b32 s39, s39, 1
  s_add_u32 s39, s39, s38
  s_add_u32 s39, s39, s33
  s_cmp_ge_u32 s38, s34
  s_cselect_b32 s47, s35, 0
  s_add_u32 s39, s39, s47
  s_cmp_ge_u32 s38, s36
  s_cselect_b32 s47, s37, 0
  s_add_u32 s39, s39, s47
  s_mul_i32 s47, s39, 3072
  s_add_u32 s32, s32, 2
  s_and_b32 s32, s32, 255
  s_waitcnt vmcnt(4)
  buffer_load_dwordx4 v[124:127], v1, s[12:15], s47 offen offset:0 nt
  v_add_f32_dpp v20, v20, v20 quad_perm:[1,0,3,2] row_mask:0xf bank_mask:0xf
  v_add_f32_dpp v23, v23, v23 quad_perm:[2,3,0,1] row_mask:0xf bank_mask:0xf
  v_add_f32_dpp v22, v22, v22 row_half_mirror row_mask:0xf bank_mask:0xf
  ds_write_b32 v36, v22 offset:576
  s_waitcnt vmcnt(5)
  v_mov_b32 v22, 0
  v_dot2c_f32_bf16 v22, v200, v12
  v_dot2c_f32_bf16 v22, v201, v13
  v_dot2c_f32_bf16 v22, v202, v14
  v_dot2c_f32_bf16 v22, v203, v15
  s_cmp_gt_u32 s44, 11
  s_cbranch_scc1 L_th25
  s_waitcnt vmcnt(4)
L_th25:
  buffer_load_dwordx4 v[128:131], v1, s[12:15], s47 offen offset:1024 nt
  v_add_f32_dpp v21, v21, v21 quad_perm:[1,0,3,2] row_mask:0xf bank_mask:0xf
  v_add_f32_dpp v20, v20, v20 quad_perm:[2,3,0,1] row_mask:0xf bank_mask:0xf
  v_add_f32_dpp v23, v23, v23 row_half_mirror row_mask:0xf bank_mask:0xf
  ds_write_b32 v36, v23 offset:608
  s_waitcnt vmcnt(5)
  v_mov_b32 v23, 0
  v_dot2c_f32_bf16 v23, v204, v16
  v_dot2c_f32_bf16 v23, v205, v17
  v_dot2c_f32_bf16 v23, v206, v18
  v_dot2c_f32_bf16 v23, v207, v19
  s_waitcnt vmcnt(4)
  buffer_load_dwordx4 v[132:135], v1, s[12:15], s47 offen offset:2048 nt
  v_add_f32_dpp v22, v22, v22 quad_perm:[1,0,3,2] row_mask:0xf bank_mask:0xf
  v_add_f32_dpp v21, v21, v21 quad_perm:[2,3,0,1] row_mask:0xf bank_mask:0xf
  v_add_f32_dpp v20, v20, v20 row_half_mirror row_mask:0xf bank_mask:0xf
  ds_write_b32 v36, v20 offset:640
  s_sub_u32 s30, s30, 1
  s_cmp_lg_u32 s30, 0
  s_cbranch_scc1 L_loopK
  s_waitcnt vmcnt(5)
  v_mov_b32 v20, 0
  v_dot2c_f32_bf16 v20, v112, v8
  v_dot2c_f32_bf16 v20, v113, v9
  v_dot2c_f32_bf16 v20, v114, v10
  v_dot2c_f32_bf16 v20, v115, v11
  s_and_b32 s38, s32, 31
  s_andn2_b32 s39, s32, 31
  s_lshl_b32 s39, s39, 1
  s_add_u32 s39, s39, s38
  s_add_u32 s39, s39, s33
  s_cmp_ge_u32 s38, s34
  s_cselect_b32 s47, s35, 0
  s_add_u32 s39, s39, s47
  s_cmp_ge_u32 s38, s36
  s_cselect_b32 s47, s37, 0
  s_add_u32 s39, s39, s47
  s_mul_i32 s47, s39, 3072
  s_add_u32 s32, s32, 2
  s_and_b32 s32, s32, 255
  buffer_load_dwordx4 v[136:139], v1, s[12:15], s47 offen offset:0 nt
  v_add_f32_dpp v23, v23, v23 quad_perm:[1,0,3,2] row_mask:0xf bank_mask:0xf
  v_add_f32_dpp v22, v22, v22 quad_perm:[2,3,0,1] row_mask:0xf bank_mask:0xf
  v_add_f32_dpp v21, v21, v21 row_half_mirror row_mask:0xf bank_mask:0xf
  ds_write_b32 v36, v21 offset:672
  s_waitcnt vmcnt(5)
  v_mov_b32 v21, 0
  v_dot2c_f32_bf16 v21, v116, v12
  v_dot2c_f32_bf16 v21, v117, v13
  v_dot2c_f32_bf16 v21, v118, v14
  v_dot2c_f32_bf16 v21, v119, v15
  buffer_load_dwordx4 v[140:143], v1, s[12:15], s47 offen offset:1024 nt
  v_add_f32_dpp v20, v20, v20 quad_perm:[1,0,3,2] row_mask:0xf bank_mask:0xf
  v_add_f32_dpp v23, v23, v23 quad_perm:[2,3,0,1] row_mask:0xf bank_mask:0xf
  v_add_f32_dpp v22, v22, v22 row_half_mirror row_mask:0xf bank_mask:0xf
  ds_write_b32 v36, v22 offset:704
  s_waitcnt vmcnt(5)
  v_mov_b32 v22, 0
  v_dot2c_f32_bf16 v22, v120, v16
  v_dot2c_f32_bf16 v22, v121, v17
  v_dot2c_f32_bf16 v22, v122, v18
  v_dot2c_f32_bf16 v22, v123, v19
  buffer_load_dwordx4 v[144:147], v1, s[12:15], s47 offen offset:2048 nt
  v_add_f32_dpp v21, v21, v21 quad_perm:[1,0,3,2] row_mask:0xf bank_mask:0xf
  v_add_f32_dpp v20, v20, v20 quad_perm:[2,3,0,1] row_mask:0xf bank_mask:0xf
  v_add_f32_dpp v23, v23, v23 row_half_mirror row_mask:0xf bank_mask:0xf
  ds_write_b32 v36, v23 offset:736
  v_add_u32 v36, 768, v36
  s_waitcnt vmcnt(5)
  v_mov_b32 v23, 0
  v_dot2c_f32_bf16 v23, v124, v8
  v_dot2c_f32_bf16 v23, v125, v9
  v_dot2c_f32_bf16 v23, v126, v10
  v_dot2c_f32_bf16 v23, v127, v11
  s_and_b32 s38, s32, 31
  s_andn2_b32 s39, s32, 31
  s_lshl_b32 s39, s39, 1
  s_add_u32 s39, s39, s38
  s_add_u32 s39, s39, s33
  s_cmp_ge_u32 s38, s34
  s_cselect_b32 s47, s35, 0
  s_add_u32 s39, s39, s47
  s_cmp_ge_u32 s38, s36
  s_cselect_b32 s47, s37, 0
  s_add_u32 s39, s39, s47
  s_mul_i32 s47, s39, 3072
  s_add_u32 s32, s32, 2
  s_and_b32 s32, s32, 255
  buffer_load_dwordx4 v[148:151], v1, s[12:15], s47 offen offset:0 nt
  v_add_f32_dpp v22, v22, v22 quad_perm:[1,0,3,2] row_mask:0xf bank_mask:0xf
  v_add_f32_dpp v21, v21, v21 quad_perm:[2,3,0,1] row_mask:0xf bank_mask:0xf
  v_add_f32_dpp v20, v20, v20 row_half_mirror row_mask:0xf bank_mask:0xf
  ds_write_b32 v36, v20 offset:0
  s_waitcnt vmcnt(5)
  v_mov_b32 v20, 0
  v_dot2c_f32_bf16 v20, v128, v12
  v_dot2c_f32_bf16 v20, v129, v13
  v_dot2c_f32_bf16 v20, v130, v14
  v_dot2c_f32_bf16 v20, v131, v15
  buffer_load_dwordx4 v[152:155], v1, s[12:15], s47 offen offset:1024 nt
  v_add_f32_dpp v23, v23, v23 quad_perm:[1,0,3,2] row_mask:0xf bank_mask:0xf
  v_add_f32_dpp v22, v22, v22 quad_perm:[2,3,0,1] row_mask:0xf bank_mask:0xf
  v_add_f32_dpp v21, v21, v21 row_half_mirror row_mask:0xf bank_mask:0xf
  ds_write_b32 v36, v21 offset:32
  s_waitcnt vmcnt(5)
  v_mov_b32 v21, 0
  v_dot2c_f32_bf16 v21, v132, v16
  v_dot2c_f32_bf16 v21, v133, v17
  v_dot2c_f32_bf16 v21, v134, v18
  v_dot2c_f32_bf16 v21, v135, v19
  buffer_load_dwordx4 v[156:159], v1, s[12:15], s47 offen offset:2048 nt
  v_add_f32_dpp v20, v20, v20 quad_perm:[1,0,3,2] row_mask:0xf bank_mask:0xf
  v_add_f32_dpp v23, v23, v23 quad_perm:[2,3,0,1] row_mask:0xf bank_mask:0xf
  v_add_f32_dpp v22, v22, v22 row_half_mirror row_mask:0xf bank_mask:0xf
  ds_write_b32 v36, v22 offset:64
  s_waitcnt vmcnt(5)
  v_mov_b32 v22, 0
  v_dot2c_f32_bf16 v22, v136, v8
  v_dot2c_f32_bf16 v22, v137, v9
  v_dot2c_f32_bf16 v22, v138, v10
  v_dot2c_f32_bf16 v22, v139, v11
  s_and_b32 s38, s32, 31
  s_andn2_b32 s39, s32, 31
  s_lshl_b32 s39, s39, 1
  s_add_u32 s39, s39, s38
  s_add_u32 s39, s39, s33
  s_cmp_ge_u32 s38, s34
  s_cselect_b32 s47, s35, 0
  s_add_u32 s39, s39, s47
  s_cmp_ge_u32 s38, s36
  s_cselect_b32 s47, s37, 0
  s_add_u32 s39, s39, s47
  s_mul_i32 s47, s39, 3072
  s_add_u32 s32, s32, 2
  s_and_b32 s32, s32, 255
  buffer_load_dwordx4 v[160:163], v1, s[12:15], s47 offen offset:0 nt
  v_add_f32_dpp v21, v21, v21 quad_perm:[1,0,3,2] row_mask:0xf bank_mask:0xf
  v_add_f32_dpp v20, v20, v20 quad_perm:[2,3,0,1] row_mask:0xf bank_mask:0xf
  v_add_f32_dpp v23, v23, v23 row_half_mirror row_mask:0xf bank_mask:0xf
  ds_write_b32 v36, v23 offset:96
  s_waitcnt vmcnt(5)
  v_mov_b32 v23, 0
  v_dot2c_f32_bf16 v23, v140, v12
  v_dot2c_f32_bf16 v23, v141, v13
  v_dot2c_f32_bf16 v23, v142, v14
  v_dot2c_f32_bf16 v23, v143, v15
  buffer_load_dwordx4 v[164:167], v1, s[12:15], s47 offen offset:1024 nt
  v_add_f32_dpp v22, v22, v22 quad_perm:[1,0,3,2] row_mask:0xf bank_mask:0xf
  v_add_f32_dpp v21, v21, v21 quad_perm:[2,3,0,1] row_mask:0xf bank_mask:0xf
  v_add_f32_dpp v20, v20, v20 row_half_mirror row_mask:0xf bank_mask:0xf
  ds_write_b32 v36, v20 offset:128
  s_waitcnt vmcnt(5)
  v_mov_b32 v20, 0
  v_dot2c_f32_bf16 v20, v144, v16
  v_dot2c_f32_bf16 v20, v145, v17
  v_dot2c_f32_bf16 v20, v146, v18
  v_dot2c_f32_bf16 v20, v147, v19
  buffer_load_dwordx4 v[168:171], v1, s[12:15], s47 offen offset:2048 nt
  v_add_f32_dpp v23, v23, v23 quad_perm:[1,0,3,2] row_mask:0xf bank_mask:0xf
  v_add_f32_dpp v22, v22, v22 quad_perm:[2,3,0,1] row_mask:0xf bank_mask:0xf
  v_add_f32_dpp v21, v21, v21 row_half_mirror row_mask:0xf bank_mask:0xf
  ds_write_b32 v36, v21 offset:160
  s_waitcnt vmcnt(5)
  v_mov_b32 v21, 0
  v_dot2c_f32_bf16 v21, v148, v8
  v_dot2c_f32_bf16 v21, v149, v9
  v_dot2c_f32_bf16 v21, v150, v10
  v_dot2c_f32_bf16 v21, v151, v11
  s_and_b32 s38, s32, 31
  s_andn2_b32 s39, s32, 31
  s_lshl_b32 s39, s39, 1
  s_add_u32 s39, s39, s38
  s_add_u32 s39, s39, s33
  s_cmp_ge_u32 s38, s34
  s_cselect_b32 s47, s35, 0
  s_add_u32 s39, s39, s47
  s_cmp_ge_u32 s38, s36
  s_cselect_b32 s47, s37, 0
  s_add_u32 s39, s39, s47
  s_mul_i32 s47, s39, 3072
  s_add_u32 s32, s32, 2
  s_and_b32 s32, s32, 255
  buffer_load_dwordx4 v[172:175], v1, s[12:15], s47 offen offset:0 nt
  v_add_f32_dpp v20, v20, v20 quad_perm:[1,0,3,2] row_mask:0xf bank_mask:0xf
  v_add_f32_dpp v23, v23, v23 quad_perm:[2,3,0,1] row_mask:0xf bank_mask:0xf
  v_add_f32_dpp v22, v22, v22 row_half_mirror row_mask:0xf bank_mask:0xf
  ds_write_b32 v36, v22 offset:192
  s_waitcnt vmcnt(5)
  v_mov_b32 v22, 0
  v_dot2c_f32_bf16 v22, v152, v12
  v_dot2c_f32_bf16 v22, v153, v13
  v_dot2c_f32_bf16 v22, v154, v14
  v_dot2c_f32_bf16 v22, v155, v15
  buffer_load_dwordx4 v[176:179], v1, s[12:15], s47 offen offset:1024 nt
  v_add_f32_dpp v21, v21, v21 quad_perm:[1,0,3,2] row_mask:0xf bank_mask:0xf
  v_add_f32_dpp v20, v20, v20 quad_perm:[2,3,0,1] row_mask:0xf bank_mask:0xf
  v_add_f32_dpp v23, v23, v23 row_half_mirror row_mask:0xf bank_mask:0xf
  ds_write_b32 v36, v23 offset:224
  s_waitcnt vmcnt(5)
  v_mov_b32 v23, 0
  v_dot2c_f32_bf16 v23, v156, v16
  v_dot2c_f32_bf16 v23, v157, v17
  v_dot2c_f32_bf16 v23, v158, v18
  v_dot2c_f32_bf16 v23, v159, v19
  buffer_load_dwordx4 v[180:183], v1, s[12:15], s47 offen offset:2048 nt
  v_add_f32_dpp v22, v22, v22 quad_perm:[1,0,3,2] row_mask:0xf bank_mask:0xf
  v_add_f32_dpp v21, v21, v21 quad_perm:[2,3,0,1] row_mask:0xf bank_mask:0xf
  v_add_f32_dpp v20, v20, v20 row_half_mirror row_mask:0xf bank_mask:0xf
  ds_write_b32 v36, v20 offset:256
  s_waitcnt vmcnt(5)
  v_mov_b32 v20, 0
  v_dot2c_f32_bf16 v20, v160, v8
  v_dot2c_f32_bf16 v20, v161, v9
  v_dot2c_f32_bf16 v20, v162, v10
  v_dot2c_f32_bf16 v20, v163, v11
  s_and_b32 s38, s32, 31
  s_andn2_b32 s39, s32, 31
  s_lshl_b32 s39, s39, 1
  s_add_u32 s39, s39, s38
  s_add_u32 s39, s39, s33
  s_cmp_ge_u32 s38, s34
  s_cselect_b32 s47, s35, 0
  s_add_u32 s39, s39, s47
  s_cmp_ge_u32 s38, s36
  s_cselect_b32 s47, s37, 0
  s_add_u32 s39, s39, s47
  s_mul_i32 s47, s39, 3072
  s_add_u32 s32, s32, 2
  s_and_b32 s32, s32, 255
  buffer_load_dwordx4 v[184:187], v1, s[12:15], s47 offen offset:0 nt
  buffer_load_dwordx4 v[188:191], v1, s[12:15], s47 offen offset:1024 nt
  v_add_f32_dpp v23, v23, v23 quad_perm:[1,0,3,2] row_mask:0xf bank_mask:0xf
  v_add_f32_dpp v22, v22, v22 quad_perm:[2,3,0,1] row_mask:0xf bank_mask:0xf
  v_add_f32_dpp v21, v21, v21 row_half_mirror row_mask:0xf bank_mask:0xf
  ds_write_b32 v36, v21 offset:288
  s_waitcnt vmcnt(6)
  v_mov_b32 v21, 0
  v_dot2c_f32_bf16 v21, v164, v12
  v_dot2c_f32_bf16 v21, v165, v13
  v_dot2c_f32_bf16 v21, v166, v14
  v_dot2c_f32_bf16 v21, v167, v15
  buffer_load_dwordx4 v[192:195], v1, s[12:15], s47 offen offset:2048 nt
  s_and_b32 s38, s32, 31
  s_andn2_b32 s39, s32, 31
  s_lshl_b32 s39, s39, 1
  s_add_u32 s39, s39, s38
  s_add_u32 s39, s39, s33
  s_cmp_ge_u32 s38, s34
  s_cselect_b32 s47, s35, 0
  s_add_u32 s39, s39, s47
  s_cmp_ge_u32 s38, s36
  s_cselect_b32 s47, s37, 0
  s_add_u32 s39, s39, s47
  s_mul_i32 s47, s39, 3072
  s_add_u32 s32, s32, 2
  s_and_b32 s32, s32, 255
  buffer_load_dwordx4 v[196:199], v1, s[12:15], s47 offen offset:0 nt
  v_add_f32_dpp v20, v20, v20 quad_perm:[1,0,3,2] row_mask:0xf bank_mask:0xf
  v_add_f32_dpp v23, v23, v23 quad_perm:[2,3,0,1] row_mask:0xf bank_mask:0xf
  v_add_f32_dpp v22, v22, v22 row_half_mirror row_mask:0xf bank_mask:0xf
  ds_write_b32 v36, v22 offset:320
  s_waitcnt vmcnt(7)
  v_mov_b32 v22, 0
  v_dot2c_f32_bf16 v22, v168, v16
  v_dot2c_f32_bf16 v22, v169, v17
  v_dot2c_f32_bf16 v22, v170, v18
  v_dot2c_f32_bf16 v22, v171, v19
  buffer_load_dwordx4 v[200:203], v1, s[12:15], s47 offen offset:1024 nt
  buffer_load_dwordx4 v[204:207], v1, s[12:15], s47 offen offset:2048 nt
  v_add_f32_dpp v21, v21, v21 quad_perm:[1,0,3,2] row_mask:0xf bank_mask:0xf
  v_add_f32_dpp v20, v20, v20 quad_perm:[2,3,0,1] row_mask:0xf bank_mask:0xf
  v_add_f32_dpp v23, v23, v23 row_half_mirror row_mask:0xf bank_mask:0xf
  ds_write_b32 v36, v23 offset:352
  s_waitcnt vmcnt(8)
  v_mov_b32 v23, 0
  v_dot2c_f32_bf16 v23, v172, v8
  v_dot2c_f32_bf16 v23, v173, v9
  v_dot2c_f32_bf16 v23, v174, v10
  v_dot2c_f32_bf16 v23, v175, v11
  s_mov_b32 s32, s46
  s_and_b32 s38, s32, 31
  s_andn2_b32 s39, s32, 31
  s_lshl_b32 s39, s39, 1
  s_add_u32 s39, s39, s38
  s_add_u32 s39, s39, s33
  s_cmp_ge_u32 s38, s34
  s_cselect_b32 s47, s35, 0
  s_add_u32 s39, s39, s47
  s_cmp_ge_u32 s38, s36
  s_cselect_b32 s47, s37, 0
  s_add_u32 s39, s39, s47
  s_mul_i32 s47, s39, 3072
  s_add_u32 s32, s32, 2
  s_and_b32 s32, s32, 255
  buffer_load_dwordx4 v[112:115], v1, s[16:19], s47 offen offset:0 nt
  buffer_load_dwordx4 v[116:119], v1, s[16:19], s47 offen offset:1024 nt
  v_add_f32_dpp v22, v22, v22 quad_perm:[1,0,3,2] row_mask:0xf bank_mask:0xf
  v_add_f32_dpp v21, v21, v21 quad_perm:[2,3,0,1] row_mask:0xf bank_mask:0xf
  v_add_f32_dpp v20, v20, v20 row_half_mirror row_mask:0xf bank_mask:0xf
  ds_write_b32 v36, v20 offset:384
  s_waitcnt vmcnt(9)
  v_mov_b32 v20, 0
  v_dot2c_f32_bf16 v20, v176, v12
  v_dot2c_f32_bf16 v20, v177, v13
  v_dot2c_f32_bf16 v20, v178, v14
  v_dot2c_f32_bf16 v20, v179, v15
  buffer_load_dwordx4 v[120:123], v1, s[16:19], s47 offen offset:2048 nt
  s_and_b32 s38, s32, 31
  s_andn2_b32 s39, s32, 31
  s_lshl_b32 s39, s39, 1
  s_add_u32 s39, s39, s38
  s_add_u32 s39, s39, s33
  s_cmp_ge_u32 s38, s34
  s_cselect_b32 s47, s35, 0
  s_add_u32 s39, s39, s47
  s_cmp_ge_u32 s38, s36
  s_cselect_b32 s47, s37, 0
  s_add_u32 s39, s39, s47
  s_mul_i32 s47, s39, 3072
  s_add_u32 s32, s32, 2
  s_and_b32 s32, s32, 255
  buffer_load_dwordx4 v[124:127], v1, s[16:19], s47 offen offset:0 nt
  v_add_f32_dpp v23, v23, v23 quad_perm:[1,0,3,2] row_mask:0xf bank_mask:0xf
  v_add_f32_dpp v22, v22, v22 quad_perm:[2,3,0,1] row_mask:0xf bank_mask:0xf
  v_add_f32_dpp v21, v21, v21 row_half_mirror row_mask:0xf bank_mask:0xf
  ds_write_b32 v36, v21 offset:416
  s_waitcnt vmcnt(10)
  v_mov_b32 v21, 0
  v_dot2c_f32_bf16 v21, v180, v16
  v_dot2c_f32_bf16 v21, v181, v17
  v_dot2c_f32_bf16 v21, v182, v18
  v_dot2c_f32_bf16 v21, v183, v19
  buffer_load_dwordx4 v[128:131], v1, s[16:19], s47 offen offset:1024 nt
  buffer_load_dwordx4 v[132:135], v1, s[16:19], s47 offen offset:2048 nt
  v_add_f32_dpp v20, v20, v20 quad_perm:[1,0,3,2] row_mask:0xf bank_mask:0xf
  v_add_f32_dpp v23, v23, v23 quad_perm:[2,3,0,1] row_mask:0xf bank_mask:0xf
  v_add_f32_dpp v22, v22, v22 row_half_mirror row_mask:0xf bank_mask:0xf
  ds_write_b32 v36, v22 offset:448
  s_waitcnt vmcnt(11)
  v_mov_b32 v22, 0
  v_dot2c_f32_bf16 v22, v184, v8
  v_dot2c_f32_bf16 v22, v185, v9
  v_dot2c_f32_bf16 v22, v186, v10
  v_dot2c_f32_bf16 v22, v187, v11
  s_and_b32 s38, s32, 31
  s_andn2_b32 s39, s32, 31
  s_lshl_b32 s39, s39, 1
  s_add_u32 s39, s39, s38
  s_add_u32 s39, s39, s33
  s_cmp_ge_u32 s38, s34
  s_cselect_b32 s47, s35, 0
  s_add_u32 s39, s39, s47
  s_cmp_ge_u32 s38, s36
  s_cselect_b32 s47, s37, 0
  s_add_u32 s39, s39, s47
  s_mul_i32 s47, s39, 3072
  s_add_u32 s32, s32, 2
  s_and_b32 s32, s32, 255
  buffer_load_dwordx4 v[136:139], v1, s[16:19], s47 offen offset:0 nt
  buffer_load_dwordx4 v[140:143], v1, s[16:19], s47 offen offset:1024 nt
  v_add_f32_dpp v21, v21, v21 quad_perm:[1,0,3,2] row_mask:0xf bank_mask:0xf
  v_add_f32_dpp v20, v20, v20 quad_perm:[2,3,0,1] row_mask:0xf bank_mask:0xf
  v_add_f32_dpp v23, v23, v23 row_half_mirror row_mask:0xf bank_mask:0xf
  ds_write_b32 v36, v23 offset:480
  s_waitcnt vmcnt(12)
  v_mov_b32 v23, 0
  v_dot2c_f32_bf16 v23, v188, v12
  v_dot2c_f32_bf16 v23, v189, v13
  v_dot2c_f32_bf16 v23, v190, v14
  v_dot2c_f32_bf16 v23, v191, v15
  buffer_load_dwordx4 v[144:147], v1, s[16:19], s47 offen offset:2048 nt
  s_and_b32 s38, s32, 31
  s_andn2_b32 s39, s32, 31
  s_lshl_b32 s39, s39, 1
  s_add_u32 s39, s39, s38
  s_add_u32 s39, s39, s33
  s_cmp_ge_u32 s38, s34
  s_cselect_b32 s47, s35, 0
  s_add_u32 s39, s39, s47
  s_cmp_ge_u32 s38, s36
  s_cselect_b32 s47, s37, 0
  s_add_u32 s39, s39, s47
  s_mul_i32 s47, s39, 3072
  s_add_u32 s32, s32, 2
  s_and_b32 s32, s32, 255
  buffer_load_dwordx4 v[148:151], v1, s[16:19], s47 offen offset:0 nt
  v_add_f32_dpp v22, v22, v22 quad_perm:[1,0,3,2] row_mask:0xf bank_mask:0xf
  v_add_f32_dpp v21, v21, v21 quad_perm:[2,3,0,1] row_mask:0xf bank_mask:0xf
  v_add_f32_dpp v20, v20, v20 row_half_mirror row_mask:0xf bank_mask:0xf
  ds_write_b32 v36, v20 offset:512
  s_waitcnt vmcnt(13)
  v_mov_b32 v20, 0
  v_dot2c_f32_bf16 v20, v192, v16
  v_dot2c_f32_bf16 v20, v193, v17
  v_dot2c_f32_bf16 v20, v194, v18
  v_dot2c_f32_bf16 v20, v195, v19
  buffer_load_dwordx4 v[152:155], v1, s[16:19], s47 offen offset:1024 nt
  buffer_load_dwordx4 v[156:159], v1, s[16:19], s47 offen offset:2048 nt
  v_add_f32_dpp v23, v23, v23 quad_perm:[1,0,3,2] row_mask:0xf bank_mask:0xf
  v_add_f32_dpp v22, v22, v22 quad_perm:[2,3,0,1] row_mask:0xf bank_mask:0xf
  v_add_f32_dpp v21, v21, v21 row_half_mirror row_mask:0xf bank_mask:0xf
  ds_write_b32 v36, v21 offset:544
  s_waitcnt vmcnt(14)
  v_mov_b32 v21, 0
  v_dot2c_f32_bf16 v21, v196, v8
  v_dot2c_f32_bf16 v21, v197, v9
  v_dot2c_f32_bf16 v21, v198, v10
  v_dot2c_f32_bf16 v21, v199, v11
  s_and_b32 s38, s32, 31
  s_andn2_b32 s39, s32, 31
  s_lshl_b32 s39, s39, 1
  s_add_u32 s39, s39, s38
  s_add_u32 s39, s39, s33
  s_cmp_ge_u32 s38, s34
  s_cselect_b32 s47, s35, 0
  s_add_u32 s39, s39, s47
  s_cmp_ge_u32 s38, s36
  s_cselect_b32 s47, s37, 0
  s_add_u32 s39, s39, s47
  s_mul_i32 s47, s39, 3072
  s_add_u32 s32, s32, 2
  s_and_b32 s32, s32, 255
  buffer_load_dwordx4 v[160:163], v1, s[16:19], s47 offen offset:0 nt
  buffer_load_dwordx4 v[164:167], v1, s[16:19], s47 offen offset:1024 nt
  v_add_f32_dpp v20, v20, v20 quad_perm:[1,0,3,2] row_mask:0xf bank_mask:0xf
  v_add_f32_dpp v23, v23, v23 quad_perm:[2,3,0,1] row_mask:0xf bank_mask:0xf
  v_add_f32_dpp v22, v22, v22 row_half_mirror row_mask:0xf bank_mask:0xf
  ds_write_b32 v36, v22 offset:576
  s_waitcnt vmcnt(15)
  v_mov_b32 v22, 0
  v_dot2c_f32_bf16 v22, v200, v12
  v_dot2c_f32_bf16 v22, v201, v13
  v_dot2c_f32_bf16 v22, v202, v14
  v_dot2c_f32_bf16 v22, v203, v15
  buffer_load_dwordx4 v[168:171], v1, s[16:19], s47 offen offset:2048 nt
  s_and_b32 s38, s32, 31
  s_andn2_b32 s39, s32, 31
  s_lshl_b32 s39, s39, 1
  s_add_u32 s39, s39, s38
  s_add_u32 s39, s39, s33
  s_cmp_ge_u32 s38, s34
  s_cselect_b32 s47, s35, 0
  s_add_u32 s39, s39, s47
  s_cmp_ge_u32 s38, s36
  s_cselect_b32 s47, s37, 0
  s_add_u32 s39, s39, s47
  s_mul_i32 s47, s39, 3072
  s_add_u32 s32, s32, 2
  s_and_b32 s32, s32, 255
  buffer_load_dwordx4 v[172:175], v1, s[16:19], s47 offen offset:0 nt
  v_add_f32_dpp v21, v21, v21 quad_perm:[1,0,3,2] row_mask:0xf bank_mask:0xf
  v_add_f32_dpp v20, v20, v20 quad_perm:[2,3,0,1] row_mask:0xf bank_mask:0xf
  v_add_f32_dpp v23, v23, v23 row_half_mirror row_mask:0xf bank_mask:0xf
  ds_write_b32 v36, v23 offset:608
  s_waitcnt vmcnt(16)
  v_mov_b32 v23, 0
  v_dot2c_f32_bf16 v23, v204, v16
  v_dot2c_f32_bf16 v23, v205, v17
  v_dot2c_f32_bf16 v23, v206, v18
  v_dot2c_f32_bf16 v23, v207, v19
  buffer_load_dwordx4 v[176:179], v1, s[16:19], s47 offen offset:1024 nt
  buffer_load_dwordx4 v[180:183], v1, s[16:19], s47 offen offset:2048 nt
  v_add_f32_dpp v22, v22, v22 quad_perm:[1,0,3,2] row_mask:0xf bank_mask:0xf
  v_add_f32_dpp v21, v21, v21 quad_perm:[2,3,0,1] row_mask:0xf bank_mask:0xf
  v_add_f32_dpp v20, v20, v20 row_half_mirror row_mask:0xf bank_mask:0xf
  ds_write_b32 v36, v20 offset:640
  s_nop 2
  v_add_f32_dpp v21, v21, v21 row_half_mirror row_mask:0xf bank_mask:0xf
  v_add_f32_dpp v22, v22, v22 quad_perm:[2,3,0,1] row_mask:0xf bank_mask:0xf
  v_add_f32_dpp v23, v23, v23 quad_perm:[1,0,3,2] row_mask:0xf bank_mask:0xf
  s_nop 0
  ds_write_b32 v36, v21 offset:672
  v_add_f32_dpp v22, v22, v22 row_half_mirror row_mask:0xf bank_mask:0xf
  v_add_f32_dpp v23, v23, v23 quad_perm:[2,3,0,1] row_mask:0xf bank_mask:0xf
  s_nop 0
  ds_write_b32 v36, v22 offset:704
  v_add_f32_dpp v23, v23, v23 row_half_mirror row_mask:0xf bank_mask:0xf
  ds_write_b32 v36, v23 offset:736
  v_and_b32 v2, 63, v0
  v_lshrrev_b32 v3, 6, v0
  v_mul_u32_u24 v3, 12288, v3
  v_mad_u32_u24 v37, v2, 12, v3
  v_lshl_add_u32 v2, v2, 2, v3
  ds_read_b32 v48, v37 offset:0
  ds_read_b32 v64, v37 offset:4
  ds_read_b32 v80, v37 offset:8
  ds_read_b32 v49, v37 offset:768
  ds_read_b32 v65, v37 offset:772
  ds_read_b32 v81, v37 offset:776
  ds_read_b32 v50, v37 offset:1536
  ds_read_b32 v66, v37 offset:1540
  ds_read_b32 v82, v37 offset:1544
  ds_read_b32 v51, v37 offset:2304
  ds_read_b32 v67, v37 offset:2308
  ds_read_b32 v83, v37 offset:2312
  ds_read_b32 v52, v37 offset:3072
  ds_read_b32 v68, v37 offset:3076
  ds_read_b32 v84, v37 offset:3080
  ds_read_b32 v53, v37 offset:3840
  ds_read_b32 v69, v37 offset:3844
  ds_read_b32 v85, v37 offset:3848
  ds_read_b32 v54, v37 offset:4608
  ds_read_b32 v70, v37 offset:4612
  ds_read_b32 v86, v37 offset:4616
  ds_read_b32 v55, v37 offset:5376
  ds_read_b32 v71, v37 offset:5380
  ds_read_b32 v87, v37 offset:5384
  ds_read_b32 v56, v37 offset:6144
  ds_read_b32 v72, v37 offset:6148
  ds_read_b32 v88, v37 offset:6152
  ds_read_b32 v57, v37 offset:6912
  ds_read_b32 v73, v37 offset:6916
  ds_read_b32 v89, v37 offset:6920
  ds_read_b32 v58, v37 offset:7680
  ds_read_b32 v74, v37 offset:7684
  ds_read_b32 v90, v37 offset:7688
  ds_read_b32 v59, v37 offset:8448
  ds_read_b32 v75, v37 offset:8452
  ds_read_b32 v91, v37 offset:8456
  ds_read_b32 v60, v37 offset:9216
  ds_read_b32 v76, v37 offset:9220
  ds_read_b32 v92, v37 offset:9224
  ds_read_b32 v61, v37 offset:9984
  ds_read_b32 v77, v37 offset:9988
  ds_read_b32 v93, v37 offset:9992
  ds_read_b32 v62, v37 offset:10752
  ds_read_b32 v78, v37 offset:10756
  ds_read_b32 v94, v37 offset:10760
  ds_read_b32 v63, v37 offset:11520
  ds_read_b32 v79, v37 offset:11524
  ds_read_b32 v95, v37 offset:11528
  s_waitcnt lgkmcnt(0)
  v_add_f32 v48, v48, v64
  v_add_f32 v49, v49, v65
  v_add_f32 v50, v50, v66
  v_add_f32 v51, v51, v67
  v_add_f32 v52, v52, v68
  v_add_f32 v53, v53, v69
  v_add_f32 v54, v54, v70
  v_add_f32 v55, v55, v71
  v_add_f32 v56, v56, v72
  v_add_f32 v57, v57, v73
  v_add_f32 v58, v58, v74
  v_add_f32 v59, v59, v75
  v_add_f32 v60, v60, v76
  v_add_f32 v61, v61, v77
  v_add_f32 v62, v62, v78
  v_add_f32 v63, v63, v79
  v_add_f32 v48, v48, v80
  v_add_f32 v49, v49, v81
  v_add_f32 v50, v50, v82
  v_add_f32 v51, v51, v83
  v_add_f32 v52, v52, v84
  v_add_f32 v53, v53, v85
  v_add_f32 v54, v54, v86
  v_add_f32 v55, v55, v87
  v_add_f32 v56, v56, v88
  v_add_f32 v57, v57, v89
  v_add_f32 v58, v58, v90
  v_add_f32 v59, v59, v91
  v_add_f32 v60, v60, v92
  v_add_f32 v61, v61, v93
  v_add_f32 v62, v62, v94
  v_add_f32 v63, v63, v95
  v_max3_f32 v34, v48, v49, v50
  v_max3_f32 v34, v34, v51, v52
  v_max3_f32 v34, v34, v53, v54
  v_max3_f32 v34, v34, v55, v56
  v_max3_f32 v34, v34, v57, v58
  v_max3_f32 v34, v34, v59, v60
  v_max3_f32 v34, v34, v61, v62
  v_max_f32 v34, v34, v63
  s_nop 1
  v_max_f32_dpp v34, v34, v34 quad_perm:[1,0,3,2] row_mask:0xf bank_mask:0xf
  s_nop 1
  v_max_f32_dpp v34, v34, v34 quad_perm:[2,3,0,1] row_mask:0xf bank_mask:0xf
  s_nop 1
  v_max_f32_dpp v34, v34, v34 row_half_mirror row_mask:0xf bank_mask:0xf
  s_nop 1
  v_max_f32_dpp v34, v34, v34 row_mirror row_mask:0xf bank_mask:0xf
  s_nop 0
  v_mov_b32 v35, v34
  s_nop 1
  v_permlane16_swap_b32 v34, v35
  s_nop 1
  v_max_f32 v34, v34, v35
  s_nop 0
  v_mov_b32 v35, v34
  s_nop 1
  v_permlane32_swap_b32 v34, v35
  s_nop 1
  v_max_f32 v34, v34, v35
  v_mul_f32 v33, s31, v34
  v_fma_f32 v48, v48, s31, -v33
  v_fma_f32 v49, v49, s31, -v33
  v_fma_f32 v50, v50, s31, -v33
  v_fma_f32 v51, v51, s31, -v33
  v_fma_f32 v52, v52, s31, -v33
  v_fma_f32 v53, v53, s31, -v33
  v_fma_f32 v54, v54, s31, -v33
  v_fma_f32 v55, v55, s31, -v33
  v_fma_f32 v56, v56, s31, -v33
  v_fma_f32 v57, v57, s31, -v33
  v_fma_f32 v58, v58, s31, -v33
  v_fma_f32 v59, v59, s31, -v33
  v_fma_f32 v60, v60, s31, -v33
  v_fma_f32 v61, v61, s31, -v33
  v_fma_f32 v62, v62, s31, -v33
  v_fma_f32 v63, v63, s31, -v33
  v_exp_f32 v48, v48
  v_exp_f32 v49, v49
  v_exp_f32 v50, v50
  v_exp_f32 v51, v51
  v_exp_f32 v52, v52
  v_exp_f32 v53, v53
  v_exp_f32 v54, v54
  v_exp_f32 v55, v55
  v_exp_f32 v56, v56
  v_exp_f32 v57, v57
  v_exp_f32 v58, v58
  v_exp_f32 v59, v59
  v_exp_f32 v60, v60
  v_exp_f32 v61, v61
  v_exp_f32 v62, v62
  v_exp_f32 v63, v63
  v_add_f32 v32, v48, v49
  v_add_f32 v32, v32, v50
  v_add_f32 v32, v32, v51
  v_add_f32 v32, v32, v52
  v_add_f32 v32, v32, v53
  v_add_f32 v32, v32, v54
  v_add_f32 v32, v32, v55
  v_add_f32 v32, v32, v56
  v_add_f32 v32, v32, v57
  v_add_f32 v32, v32, v58
  v_add_f32 v32, v32, v59
  v_add_f32 v32, v32, v60
  v_add_f32 v32, v32, v61
  v_add_f32 v32, v32, v62
  v_add_f32 v32, v32, v63
  v_cvt_pk_bf16_f32 v48, v48, v48
  v_cvt_pk_bf16_f32 v49, v49, v49
  v_cvt_pk_bf16_f32 v50, v50, v50
  v_cvt_pk_bf16_f32 v51, v51, v51
  v_cvt_pk_bf16_f32 v52, v52, v52
  v_cvt_pk_bf16_f32 v53, v53, v53
  v_cvt_pk_bf16_f32 v54, v54, v54
  v_cvt_pk_bf16_f32 v55, v55, v55
  v_cvt_pk_bf16_f32 v56, v56, v56
  v_cvt_pk_bf16_f32 v57, v57, v57
  v_cvt_pk_bf16_f32 v58, v58, v58
  v_cvt_pk_bf16_f32 v59, v59, v59
  v_cvt_pk_bf16_f32 v60, v60, v60
  v_cvt_pk_bf16_f32 v61, v61, v61
  v_cvt_pk_bf16_f32 v62, v62, v62
  v_cvt_pk_bf16_f32 v63, v63, v63
  ds_write_b32 v2, v48 offset:0
  ds_write_b32 v2, v49 offset:256
  ds_write_b32 v2, v50 offset:512
  ds_write_b32 v2, v51 offset:768
  ds_write_b32 v2, v52 offset:1024
  ds_write_b32 v2, v53 offset:1280
  ds_write_b32 v2, v54 offset:1536
  ds_write_b32 v2, v55 offset:1792
  ds_write_b32 v2, v56 offset:2048
  ds_write_b32 v2, v57 offset:2304
  ds_write_b32 v2, v58 offset:2560
  ds_write_b32 v2, v59 offset:2816
  ds_write_b32 v2, v60 offset:3072
  ds_write_b32 v2, v61 offset:3328
  ds_write_b32 v2, v62 offset:3584
  ds_write_b32 v2, v63 offset:3840
  ds_read_b32 v20, v38 offset:0
  ds_read_b32 v21, v39 offset:0
  s_waitcnt lgkmcnt(0)
  v_and_b32 v24, v20, v4
  v_and_b32 v25, v20, v5
  v_and_b32 v26, v20, v6
  v_and_b32 v27, v20, v7
  ds_read_b32 v22, v38 offset:20
  s_waitcnt vmcnt(17)
  v_mfma_f32_32x32x16_bf16 v[64:79], v[24:27], v[112:115], 0
  s_nop 1
  v_add_f32_dpp v32, v32, v32 quad_perm:[1,0,3,2] row_mask:0xf bank_mask:0xf
  s_waitcnt lgkmcnt(0)
  v_and_b32 v28, v21, v4
  v_and_b32 v29, v21, v5
  v_and_b32 v30, v21, v6
  v_and_b32 v31, v21, v7
  ds_read_b32 v20, v38 offset:32
  s_waitcnt vmcnt(16)
  v_mfma_f32_32x32x16_bf16 v[80:95], v[28:31], v[116:119], 0
  s_nop 1
  v_add_f32_dpp v32, v32, v32 quad_perm:[2,3,0,1] row_mask:0xf bank_mask:0xf
  s_waitcnt lgkmcnt(0)
  v_and_b32 v24, v22, v4
  v_and_b32 v25, v22, v5
  v_and_b32 v26, v22, v6
  v_and_b32 v27, v22, v7
  ds_read_b32 v21, v39 offset:32
  s_waitcnt vmcnt(15)
  v_mfma_f32_32x32x16_bf16 v[96:111], v[24:27], v[120:123], 0
  s_nop 1
  v_add_f32_dpp v32, v32, v32 row_half_mirror row_mask:0xf bank_mask:0xf
  s_waitcnt lgkmcnt(0)
  v_and_b32 v28, v20, v4
  v_and_b32 v29, v20, v5
  v_and_b32 v30, v20, v6
  v_and_b32 v31, v20, v7
  ds_read_b32 v22, v38 offset:52
  s_waitcnt vmcnt(14)
  v_mfma_f32_32x32x16_bf16 v[64:79], v[28:31], v[124:127], v[64:79]
  s_nop 1
  v_add_f32_dpp v32, v32, v32 row_mirror row_mask:0xf bank_mask:0xf
  s_waitcnt lgkmcnt(0)
  v_and_b32 v24, v21, v4
  v_and_b32 v25, v21, v5
  v_and_b32 v26, v21, v6
  v_and_b32 v27, v21, v7
  ds_read_b32 v20, v38 offset:64
  s_waitcnt vmcnt(13)
  v_mfma_f32_32x32x16_bf16 v[80:95], v[24:27], v[128:131], v[80:95]
  s_nop 0
  v_mov_b32 v35, v32
  s_nop 1
  v_permlane16_swap_b32 v32, v35
  s_nop 1
  v_add_f32 v32, v32, v35
  s_waitcnt lgkmcnt(0)
  v_and_b32 v28, v22, v4
  v_and_b32 v29, v22, v5
  v_and_b32 v30, v22, v6
  v_and_b32 v31, v22, v7
  ds_read_b32 v21, v39 offset:64
  s_waitcnt vmcnt(12)
  v_mfma_f32_32x32x16_bf16 v[96:111], v[28:31], v[132:135], v[96:111]
  s_nop 0
  v_mov_b32 v35, v32
  s_nop 1
  v_permlane32_swap_b32 v32, v35
  s_nop 1
  v_add_f32 v32, v32, v35
  s_waitcnt lgkmcnt(0)
  v_and_b32 v24, v20, v4
  v_and_b32 v25, v20, v5
  v_and_b32 v26, v20, v6
  v_and_b32 v27, v20, v7
  ds_read_b32 v22, v38 offset:84
  s_waitcnt vmcnt(11)
  v_mfma_f32_32x32x16_bf16 v[64:79], v[24:27], v[136:139], v[64:79]
  v_lshrrev_b32 v2, 6, v0
  v_lshlrev_b32 v44, 3, v2
  v_mov_b32 v34, v33
  v_mov_b32 v35, v32
  s_waitcnt lgkmcnt(0)
  v_and_b32 v28, v21, v4
  v_and_b32 v29, v21, v5
  v_and_b32 v30, v21, v6
  v_and_b32 v31, v21, v7
  ds_read_b32 v20, v38 offset:96
  s_waitcnt vmcnt(10)
  v_mfma_f32_32x32x16_bf16 v[80:95], v[28:31], v[140:143], v[80:95]
  ds_write_b64 v44, v[34:35] offset:49152
  s_waitcnt lgkmcnt(0)
  v_and_b32 v24, v22, v4
  v_and_b32 v25, v22, v5
  v_and_b32 v26, v22, v6
  v_and_b32 v27, v22, v7
  ds_read_b32 v21, v39 offset:96
  s_waitcnt vmcnt(9)
  v_mfma_f32_32x32x16_bf16 v[96:111], v[24:27], v[144:147], v[96:111]
  v_mul_u32_u24 v2, 12288, v2
  v_bfe_u32 v37, v0, 3, 2
  v_mul_u32_u24 v40, 768, v37
  v_add_u32 v2, v2, v40
  s_waitcnt lgkmcnt(0)
  v_and_b32 v28, v20, v4
  v_and_b32 v29, v20, v5
  v_and_b32 v30, v20, v6
  v_and_b32 v31, v20, v7
  ds_read_b32 v22, v38 offset:116
  s_waitcnt vmcnt(8)
  v_mfma_f32_32x32x16_bf16 v[64:79], v[28:31], v[148:151], v[64:79]
  v_and_b32 v40, 7, v0
  v_lshl_add_u32 v2, v40, 5, v2
  v_bfe_u32 v40, v0, 5, 1
  v_lshl_add_u32 v2, v40, 4, v2
  s_waitcnt lgkmcnt(0)
  v_and_b32 v24, v21, v4
  v_and_b32 v25, v21, v5
  v_and_b32 v26, v21, v6
  v_and_b32 v27, v21, v7
  ds_read_b32 v20, v38 offset:128
  s_waitcnt vmcnt(7)
  v_mfma_f32_32x32x16_bf16 v[80:95], v[24:27], v[152:155], v[80:95]
  v_lshrrev_b32 v3, 1, v37
  v_and_b32 v3, v3, v37
  v_and_b32 v3, 1, v3
  v_add_u32 v37, v37, v3
  v_and_b32 v37, 3, v37
  v_lshl_add_u32 v40, v37, 8, v2
  s_waitcnt lgkmcnt(0)
  v_and_b32 v28, v22, v4
  v_and_b32 v29, v22, v5
  v_and_b32 v30, v22, v6
  v_and_b32 v31, v22, v7
  ds_read_b32 v21, v39 offset:128
  s_waitcnt vmcnt(6)
  v_mfma_f32_32x32x16_bf16 v[96:111], v[28:31], v[156:159], v[96:111]
  v_add_u32 v37, 1, v37
  v_lshrrev_b32 v3, 1, v37
  v_and_b32 v3, v3, v37
  v_and_b32 v3, 1, v3
  v_add_u32 v37, v37, v3
  v_and_b32 v37, 3, v37
  v_lshl_add_u32 v41, v37, 8, v2
  s_waitcnt lgkmcnt(0)
  v_and_b32 v24, v20, v4
  v_and_b32 v25, v20, v5
  v_and_b32 v26, v20, v6
  v_and_b32 v27, v20, v7
  ds_read_b32 v22, v38 offset:148
  s_waitcnt vmcnt(5)
  v_mfma_f32_32x32x16_bf16 v[64:79], v[24:27], v[160:163], v[64:79]
  s_and_b32 s38, s32, 31
  s_andn2_b32 s39, s32, 31
  s_lshl_b32 s39, s39, 1
  s_add_u32 s39, s39, s38
  s_add_u32 s39, s39, s33
  s_cmp_ge_u32 s38, s34
  s_cselect_b32 s47, s35, 0
  s_add_u32 s39, s39, s47
  s_cmp_ge_u32 s38, s36
  s_cselect_b32 s47, s37, 0
  s_add_u32 s39, s39, s47
  s_mul_i32 s47, s39, 3072
  s_add_u32 s32, s32, 2
  s_and_b32 s32, s32, 255
  buffer_load_dwordx4 v[184:187], v1, s[16:19], s47 offen offset:0 nt
  v_add_u32 v37, 1, v37
  v_lshrrev_b32 v3, 1, v37
  v_and_b32 v3, v3, v37
  v_and_b32 v3, 1, v3
  v_add_u32 v37, v37, v3
  v_and_b32 v37, 3, v37
  v_lshl_add_u32 v42, v37, 8, v2
  s_waitcnt lgkmcnt(0)
  v_and_b32 v28, v21, v4
  v_and_b32 v29, v21, v5
  v_and_b32 v30, v21, v6
  v_and_b32 v31, v21, v7
  ds_read_b32 v20, v38 offset:160
  s_waitcnt vmcnt(5)
  v_mfma_f32_32x32x16_bf16 v[80:95], v[28:31], v[164:167], v[80:95]
  buffer_load_dwordx4 v[188:191], v1, s[16:19], s47 offen offset:1024 nt
  v_min_u32 v43, 95, v0
  v_lshlrev_b32 v43, 3, v43
  v_lshlrev_b32 v45, 2, v0
  v_and_b32 v44, 3, v0
  v_lshlrev_b32 v44, 3, v44
  s_waitcnt lgkmcnt(0)
  v_and_b32 v24, v22, v4
  v_and_b32 v25, v22, v5
  v_and_b32 v26, v22, v6
  v_and_b32 v27, v22, v7
  ds_read_b32 v21, v39 offset:160
  s_waitcnt vmcnt(5)
  v_mfma_f32_32x32x16_bf16 v[96:111], v[24:27], v[168:171], v[96:111]
  buffer_load_dwordx4 v[192:195], v1, s[16:19], s47 offen offset:2048 nt
  s_waitcnt lgkmcnt(0)
  v_and_b32 v28, v20, v4
  v_and_b32 v29, v20, v5
  v_and_b32 v30, v20, v6
  v_and_b32 v31, v20, v7
  ds_read_b32 v22, v38 offset:180
  s_waitcnt vmcnt(5)
  v_mfma_f32_32x32x16_bf16 v[64:79], v[28:31], v[172:175], v[64:79]
  s_and_b32 s38, s32, 31
  s_andn2_b32 s39, s32, 31
  s_lshl_b32 s39, s39, 1
  s_add_u32 s39, s39, s38
  s_add_u32 s39, s39, s33
  s_cmp_ge_u32 s38, s34
  s_cselect_b32 s47, s35, 0
  s_add_u32 s39, s39, s47
  s_cmp_ge_u32 s38, s36
  s_cselect_b32 s47, s37, 0
  s_add_u32 s39, s39, s47
  s_mul_i32 s47, s39, 3072
  s_add_u32 s32, s32, 2
  s_and_b32 s32, s32, 255
  buffer_load_dwordx4 v[196:199], v1, s[16:19], s47 offen offset:0 nt
  s_waitcnt lgkmcnt(0)
  v_and_b32 v24, v21, v4
  v_and_b32 v25, v21, v5
  v_and_b32 v26, v21, v6
  v_and_b32 v27, v21, v7
  ds_read_b32 v20, v38 offset:192
  s_waitcnt vmcnt(5)
  v_mfma_f32_32x32x16_bf16 v[80:95], v[24:27], v[176:179], v[80:95]
  buffer_load_dwordx4 v[200:203], v1, s[16:19], s47 offen offset:1024 nt
  s_waitcnt lgkmcnt(0)
  v_and_b32 v28, v22, v4
  v_and_b32 v29, v22, v5
  v_and_b32 v30, v22, v6
  v_and_b32 v31, v22, v7
  ds_read_b32 v21, v39 offset:192
  s_waitcnt vmcnt(5)
  v_mfma_f32_32x32x16_bf16 v[96:111], v[28:31], v[180:183], v[96:111]
  buffer_load_dwordx4 v[204:207], v1, s[16:19], s47 offen offset:2048 nt
  s_waitcnt lgkmcnt(0)
  v_and_b32 v24, v20, v4
  v_and_b32 v25, v20, v5
  v_and_b32 v26, v20, v6
  v_and_b32 v27, v20, v7
  ds_read_b32 v22, v38 offset:212
  s_waitcnt vmcnt(5)
  v_mfma_f32_32x32x16_bf16 v[64:79], v[24:27], v[184:187], v[64:79]
  s_and_b32 s38, s32, 31
  s_andn2_b32 s39, s32, 31
  s_lshl_b32 s39, s39, 1
  s_add_u32 s39, s39, s38
  s_add_u32 s39, s39, s33
  s_cmp_ge_u32 s38, s34
  s_cselect_b32 s47, s35, 0
  s_add_u32 s39, s39, s47
  s_cmp_ge_u32 s38, s36
  s_cselect_b32 s47, s37, 0
  s_add_u32 s39, s39, s47
  s_mul_i32 s47, s39, 3072
  s_add_u32 s32, s32, 2
  s_and_b32 s32, s32, 255
  buffer_load_dwordx4 v[112:115], v1, s[16:19], s47 offen offset:0 nt
  s_waitcnt lgkmcnt(0)
  v_and_b32 v28, v21, v4
  v_and_b32 v29, v21, v5
  v_and_b32 v30, v21, v6
  v_and_b32 v31, v21, v7
  ds_read_b32 v20, v38 offset:224
  s_waitcnt vmcnt(5)
  v_mfma_f32_32x32x16_bf16 v[80:95], v[28:31], v[188:191], v[80:95]
  buffer_load_dwordx4 v[116:119], v1, s[16:19], s47 offen offset:1024 nt
  s_waitcnt lgkmcnt(0)
  v_and_b32 v24, v22, v4
  v_and_b32 v25, v22, v5
  v_and_b32 v26, v22, v6
  v_and_b32 v27, v22, v7
  ds_read_b32 v21, v39 offset:224
  s_waitcnt vmcnt(5)
  v_mfma_f32_32x32x16_bf16 v[96:111], v[24:27], v[192:195], v[96:111]
  buffer_load_dwordx4 v[120:123], v1, s[16:19], s47 offen offset:2048 nt
  s_waitcnt lgkmcnt(0)
  v_and_b32 v28, v20, v4
  v_and_b32 v29, v20, v5
  v_and_b32 v30, v20, v6
  v_and_b32 v31, v20, v7
  ds_read_b32 v22, v38 offset:244
  s_waitcnt vmcnt(5)
  v_mfma_f32_32x32x16_bf16 v[64:79], v[28:31], v[196:199], v[64:79]
  s_and_b32 s38, s32, 31
  s_andn2_b32 s39, s32, 31
  s_lshl_b32 s39, s39, 1
  s_add_u32 s39, s39, s38
  s_add_u32 s39, s39, s33
  s_cmp_ge_u32 s38, s34
  s_cselect_b32 s47, s35, 0
  s_add_u32 s39, s39, s47
  s_cmp_ge_u32 s38, s36
  s_cselect_b32 s47, s37, 0
  s_add_u32 s39, s39, s47
  s_mul_i32 s47, s39, 3072
  s_add_u32 s32, s32, 2
  s_and_b32 s32, s32, 255
  buffer_load_dwordx4 v[124:127], v1, s[16:19], s47 offen offset:0 nt
  s_waitcnt lgkmcnt(0)
  v_and_b32 v24, v21, v4
  v_and_b32 v25, v21, v5
  v_and_b32 v26, v21, v6
  v_and_b32 v27, v21, v7
  ds_read_b32 v20, v38 offset:256
  s_waitcnt vmcnt(5)
  v_mfma_f32_32x32x16_bf16 v[80:95], v[24:27], v[200:203], v[80:95]
  buffer_load_dwordx4 v[128:131], v1, s[16:19], s47 offen offset:1024 nt
  s_waitcnt lgkmcnt(0)
  v_and_b32 v28, v22, v4
  v_and_b32 v29, v22, v5
  v_and_b32 v30, v22, v6
  v_and_b32 v31, v22, v7
  ds_read_b32 v21, v39 offset:256
  s_waitcnt vmcnt(5)
  v_mfma_f32_32x32x16_bf16 v[96:111], v[28:31], v[204:207], v[96:111]
  buffer_load_dwordx4 v[132:135], v1, s[16:19], s47 offen offset:2048 nt
  v_add_u32 v38, 256, v38
  v_add_u32 v39, 256, v39
  s_waitcnt lgkmcnt(0)
  s_barrier
  s_waitcnt lgkmcnt(0)
  v_and_b32 v24, v20, v4
  v_and_b32 v25, v20, v5
  v_and_b32 v26, v20, v6
  v_and_b32 v27, v20, v7
  ds_read_b32 v22, v38 offset:20
  s_waitcnt vmcnt(5)
  v_mfma_f32_32x32x16_bf16 v[64:79], v[24:27], v[112:115], v[64:79]
  s_and_b32 s38, s32, 31
  s_andn2_b32 s39, s32, 31
  s_lshl_b32 s39, s39, 1
  s_add_u32 s39, s39, s38
  s_add_u32 s39, s39, s33
  s_cmp_ge_u32 s38, s34
  s_cselect_b32 s47, s35, 0
  s_add_u32 s39, s39, s47
  s_cmp_ge_u32 s38, s36
  s_cselect_b32 s47, s37, 0
  s_add_u32 s39, s39, s47
  s_mul_i32 s47, s39, 3072
  s_add_u32 s32, s32, 2
  s_and_b32 s32, s32, 255
  s_cmp_gt_u32 s44, 0
  s_cbranch_scc1 L_th26
  s_waitcnt vmcnt(4)
L_th26:
  buffer_load_dwordx4 v[136:139], v1, s[16:19], s47 offen offset:0 nt
  ds_read_b64 v[34:35], v44 offset:49152
  s_waitcnt lgkmcnt(0)
  v_and_b32 v28, v21, v4
  v_and_b32 v29, v21, v5
  v_and_b32 v30, v21, v6
  v_and_b32 v31, v21, v7
  ds_read_b32 v20, v38 offset:32
  s_waitcnt vmcnt(5)
  v_mfma_f32_32x32x16_bf16 v[80:95], v[28:31], v[116:119], v[80:95]
  s_waitcnt vmcnt(4)
  buffer_load_dwordx4 v[140:143], v1, s[16:19], s47 offen offset:1024 nt
  s_waitcnt lgkmcnt(0)
  v_mov_b32 v37, v34
  s_waitcnt lgkmcnt(0)
  v_and_b32 v24, v22, v4
  v_and_b32 v25, v22, v5
  v_and_b32 v26, v22, v6
  v_and_b32 v27, v22, v7
  ds_read_b32 v21, v39 offset:32
  s_waitcnt vmcnt(5)
  v_mfma_f32_32x32x16_bf16 v[96:111], v[24:27], v[120:123], v[96:111]
  s_cmp_gt_u32 s44, 1
  s_cbranch_scc1 L_th27
  s_waitcnt vmcnt(4)
L_th27:
  buffer_load_dwordx4 v[144:147], v1, s[16:19], s47 offen offset:2048 nt
  s_nop 1
  v_max_f32_dpp v37, v37, v37 quad_perm:[1,0,3,2] row_mask:0xf bank_mask:0xf
  s_waitcnt lgkmcnt(0)
  v_and_b32 v28, v20, v4
  v_and_b32 v29, v20, v5
  v_and_b32 v30, v20, v6
  v_and_b32 v31, v20, v7
  ds_read_b32 v22, v38 offset:52
  s_waitcnt vmcnt(5)
  v_mfma_f32_32x32x16_bf16 v[64:79], v[28:31], v[124:127], v[64:79]
  s_and_b32 s38, s32, 31
  s_andn2_b32 s39, s32, 31
  s_lshl_b32 s39, s39, 1
  s_add_u32 s39, s39, s38
  s_add_u32 s39, s39, s33
  s_cmp_ge_u32 s38, s34
  s_cselect_b32 s47, s35, 0
  s_add_u32 s39, s39, s47
  s_cmp_ge_u32 s38, s36
  s_cselect_b32 s47, s37, 0
  s_add_u32 s39, s39, s47
  s_mul_i32 s47, s39, 3072
  s_add_u32 s32, s32, 2
  s_and_b32 s32, s32, 255
  s_waitcnt vmcnt(4)
  buffer_load_dwordx4 v[148:151], v1, s[16:19], s47 offen offset:0 nt
  s_nop 1
  v_max_f32_dpp v37, v37, v37 quad_perm:[2,3,0,1] row_mask:0xf bank_mask:0xf
  s_waitcnt lgkmcnt(0)
  v_and_b32 v24, v21, v4
  v_and_b32 v25, v21, v5
  v_and_b32 v26, v21, v6
  v_and_b32 v27, v21, v7
  ds_read_b32 v20, v38 offset:64
  s_waitcnt vmcnt(5)
  v_mfma_f32_32x32x16_bf16 v[80:95], v[24:27], v[128:131], v[80:95]
  s_cmp_gt_u32 s44, 2
  s_cbranch_scc1 L_th28
  s_waitcnt vmcnt(4)
L_th28:
  buffer_load_dwordx4 v[152:155], v1, s[16:19], s47 offen offset:1024 nt
  v_sub_f32 v34, v34, v37
  v_exp_f32 v34, v34
  s_nop 0
  v_mul_f32 v35, v35, v34
  s_waitcnt lgkmcnt(0)
  v_and_b32 v28, v22, v4
  v_and_b32 v29, v22, v5
  v_and_b32 v30, v22, v6
  v_and_b32 v31, v22, v7
  ds_read_b32 v21, v39 offset:64
  s_waitcnt vmcnt(5)
  v_mfma_f32_32x32x16_bf16 v[96:111], v[28:31], v[132:135], v[96:111]
  s_waitcnt vmcnt(4)
  buffer_load_dwordx4 v[156:159], v1, s[16:19], s47 offen offset:2048 nt
  s_nop 1
  v_add_f32_dpp v35, v35, v35 quad_perm:[1,0,3,2] row_mask:0xf bank_mask:0xf
  s_waitcnt lgkmcnt(0)
  v_and_b32 v24, v20, v4
  v_and_b32 v25, v20, v5
  v_and_b32 v26, v20, v6
  v_and_b32 v27, v20, v7
  ds_read_b32 v22, v38 offset:84
  s_waitcnt vmcnt(5)
  v_mfma_f32_32x32x16_bf16 v[64:79], v[24:27], v[136:139], v[64:79]
  s_and_b32 s38, s32, 31
  s_andn2_b32 s39, s32, 31
  s_lshl_b32 s39, s39, 1
  s_add_u32 s39, s39, s38
  s_add_u32 s39, s39, s33
  s_cmp_ge_u32 s38, s34
  s_cselect_b32 s47, s35, 0
  s_add_u32 s39, s39, s47
  s_cmp_ge_u32 s38, s36
  s_cselect_b32 s47, s37, 0
  s_add_u32 s39, s39, s47
  s_mul_i32 s47, s39, 3072
  s_add_u32 s32, s32, 2
  s_and_b32 s32, s32, 255
  s_cmp_gt_u32 s44, 3
  s_cbranch_scc1 L_th29
  s_waitcnt vmcnt(4)
L_th29:
  buffer_load_dwordx4 v[160:163], v1, s[16:19], s47 offen offset:0 nt
  s_nop 1
  v_add_f32_dpp v35, v35, v35 quad_perm:[2,3,0,1] row_mask:0xf bank_mask:0xf
  s_waitcnt lgkmcnt(0)
  v_and_b32 v28, v21, v4
  v_and_b32 v29, v21, v5
  v_and_b32 v30, v21, v6
  v_and_b32 v31, v21, v7
  ds_read_b32 v20, v38 offset:96
  s_waitcnt vmcnt(5)
  v_mfma_f32_32x32x16_bf16 v[80:95], v[28:31], v[140:143], v[80:95]
  s_waitcnt vmcnt(4)
  buffer_load_dwordx4 v[164:167], v1, s[16:19], s47 offen offset:1024 nt
  v_rcp_f32 v35, v35
  s_nop 0
  v_mul_f32 v34, v34, v35
  s_nop 0
  v_readlane_b32 s40, v34, 0
  v_readlane_b32 s41, v34, 1
  v_readlane_b32 s42, v34, 2
  v_readlane_b32 s43, v34, 3
  s_waitcnt lgkmcnt(0)
  v_and_b32 v24, v22, v4
  v_and_b32 v25, v22, v5
  v_and_b32 v26, v22, v6
  v_and_b32 v27, v22, v7
  ds_read_b32 v21, v39 offset:96
  s_waitcnt vmcnt(5)
  v_mfma_f32_32x32x16_bf16 v[96:111], v[24:27], v[144:147], v[96:111]
  s_cmp_gt_u32 s44, 4
  s_cbranch_scc1 L_th30
  s_waitcnt vmcnt(4)
L_th30:
  buffer_load_dwordx4 v[168:171], v1, s[16:19], s47 offen offset:2048 nt
  s_waitcnt lgkmcnt(0)
  v_and_b32 v28, v20, v4
  v_and_b32 v29, v20, v5
  v_and_b32 v30, v20, v6
  v_and_b32 v31, v20, v7
  ds_read_b32 v22, v38 offset:116
  s_waitcnt vmcnt(5)
  v_mfma_f32_32x32x16_bf16 v[64:79], v[28:31], v[148:151], v[64:79]
  s_and_b32 s38, s32, 31
  s_andn2_b32 s39, s32, 31
  s_lshl_b32 s39, s39, 1
  s_add_u32 s39, s39, s38
  s_add_u32 s39, s39, s33
  s_cmp_ge_u32 s38, s34
  s_cselect_b32 s47, s35, 0
  s_add_u32 s39, s39, s47
  s_cmp_ge_u32 s38, s36
  s_cselect_b32 s47, s37, 0
  s_add_u32 s39, s39, s47
  s_mul_i32 s47, s39, 3072
  s_add_u32 s32, s32, 2
  s_and_b32 s32, s32, 255
  s_waitcnt vmcnt(4)
  buffer_load_dwordx4 v[172:175], v1, s[16:19], s47 offen offset:0 nt
  s_waitcnt lgkmcnt(0)
  v_and_b32 v24, v21, v4
  v_and_b32 v25, v21, v5
  v_and_b32 v26, v21, v6
  v_and_b32 v27, v21, v7
  ds_read_b32 v20, v38 offset:128
  s_waitcnt vmcnt(5)
  v_mfma_f32_32x32x16_bf16 v[80:95], v[24:27], v[152:155], v[80:95]
  s_cmp_gt_u32 s44, 5
  s_cbranch_scc1 L_th31
  s_waitcnt vmcnt(4)
L_th31:
  buffer_load_dwordx4 v[176:179], v1, s[16:19], s47 offen offset:1024 nt
  s_waitcnt lgkmcnt(0)
  v_and_b32 v28, v22, v4
  v_and_b32 v29, v22, v5
  v_and_b32 v30, v22, v6
  v_and_b32 v31, v22, v7
  ds_read_b32 v21, v39 offset:128
  s_waitcnt vmcnt(5)
  v_mfma_f32_32x32x16_bf16 v[96:111], v[28:31], v[156:159], v[96:111]
  s_waitcnt vmcnt(4)
  buffer_load_dwordx4 v[180:183], v1, s[16:19], s47 offen offset:2048 nt
  s_waitcnt lgkmcnt(0)
  v_and_b32 v24, v20, v4
  v_and_b32 v25, v20, v5
  v_and_b32 v26, v20, v6
  v_and_b32 v27, v20, v7
  ds_read_b32 v22, v38 offset:148
  s_waitcnt vmcnt(5)
  v_mfma_f32_32x32x16_bf16 v[64:79], v[24:27], v[160:163], v[64:79]
  s_and_b32 s38, s32, 31
  s_andn2_b32 s39, s32, 31
  s_lshl_b32 s39, s39, 1
  s_add_u32 s39, s39, s38
  s_add_u32 s39, s39, s33
  s_cmp_ge_u32 s38, s34
  s_cselect_b32 s47, s35, 0
  s_add_u32 s39, s39, s47
  s_cmp_ge_u32 s38, s36
  s_cselect_b32 s47, s37, 0
  s_add_u32 s39, s39, s47
  s_mul_i32 s47, s39, 3072
  s_add_u32 s32, s32, 2
  s_and_b32 s32, s32, 255
  s_cmp_gt_u32 s44, 6
  s_cbranch_scc1 L_th32
  s_waitcnt vmcnt(4)
L_th32:
  buffer_load_dwordx4 v[184:187], v1, s[16:19], s47 offen offset:0 nt
  s_waitcnt lgkmcnt(0)
  v_and_b32 v28, v21, v4
  v_and_b32 v29, v21, v5
  v_and_b32 v30, v21, v6
  v_and_b32 v31, v21, v7
  ds_read_b32 v20, v38 offset:160
  s_waitcnt vmcnt(5)
  v_mfma_f32_32x32x16_bf16 v[80:95], v[28:31], v[164:167], v[80:95]
  s_waitcnt vmcnt(4)
  buffer_load_dwordx4 v[188:191], v1, s[16:19], s47 offen offset:1024 nt
  s_waitcnt lgkmcnt(0)
  v_and_b32 v24, v22, v4
  v_and_b32 v25, v22, v5
  v_and_b32 v26, v22, v6
  v_and_b32 v27, v22, v7
  ds_read_b32 v21, v39 offset:160
  s_waitcnt vmcnt(5)
  v_mfma_f32_32x32x16_bf16 v[96:111], v[24:27], v[168:171], v[96:111]
  s_cmp_gt_u32 s44, 7
  s_cbranch_scc1 L_th33
  s_waitcnt vmcnt(4)
L_th33:
  buffer_load_dwordx4 v[192:195], v1, s[16:19], s47 offen offset:2048 nt
  s_waitcnt lgkmcnt(0)
  v_and_b32 v28, v20, v4
  v_and_b32 v29, v20, v5
  v_and_b32 v30, v20, v6
  v_and_b32 v31, v20, v7
  ds_read_b32 v22, v38 offset:180
  s_waitcnt vmcnt(5)
  v_mfma_f32_32x32x16_bf16 v[64:79], v[28:31], v[172:175], v[64:79]
  s_and_b32 s38, s32, 31
  s_andn2_b32 s39, s32, 31
  s_lshl_b32 s39, s39, 1
  s_add_u32 s39, s39, s38
  s_add_u32 s39, s39, s33
  s_cmp_ge_u32 s38, s34
  s_cselect_b32 s47, s35, 0
  s_add_u32 s39, s39, s47
  s_cmp_ge_u32 s38, s36
  s_cselect_b32 s47, s37, 0
  s_add_u32 s39, s39, s47
  s_mul_i32 s47, s39, 3072
  s_add_u32 s32, s32, 2
  s_and_b32 s32, s32, 255
  s_waitcnt vmcnt(4)
  buffer_load_dwordx4 v[196:199], v1, s[16:19], s47 offen offset:0 nt
  s_waitcnt lgkmcnt(0)
  v_and_b32 v24, v21, v4
  v_and_b32 v25, v21, v5
  v_and_b32 v26, v21, v6
  v_and_b32 v27, v21, v7
  ds_read_b32 v20, v38 offset:192
  s_waitcnt vmcnt(5)
  v_mfma_f32_32x32x16_bf16 v[80:95], v[24:27], v[176:179], v[80:95]
  s_cmp_gt_u32 s44, 8
  s_cbranch_scc1 L_th34
  s_waitcnt vmcnt(4)
L_th34:
  buffer_load_dwordx4 v[200:203], v1, s[16:19], s47 offen offset:1024 nt
  s_waitcnt lgkmcnt(0)
  v_and_b32 v28, v22, v4
  v_and_b32 v29, v22, v5
  v_and_b32 v30, v22, v6
  v_and_b32 v31, v22, v7
  ds_read_b32 v21, v39 offset:192
  s_waitcnt vmcnt(5)
  v_mfma_f32_32x32x16_bf16 v[96:111], v[28:31], v[180:183], v[96:111]
  s_waitcnt vmcnt(4)
  buffer_load_dwordx4 v[204:207], v1, s[16:19], s47 offen offset:2048 nt
  s_waitcnt lgkmcnt(0)
  v_and_b32 v24, v20, v4
  v_and_b32 v25, v20, v5
  v_and_b32 v26, v20, v6
  v_and_b32 v27, v20, v7
  ds_read_b32 v22, v38 offset:212
  s_waitcnt vmcnt(5)
  v_mfma_f32_32x32x16_bf16 v[64:79], v[24:27], v[184:187], v[64:79]
  s_and_b32 s38, s32, 31
  s_andn2_b32 s39, s32, 31
  s_lshl_b32 s39, s39, 1
  s_add_u32 s39, s39, s38
  s_add_u32 s39, s39, s33
  s_cmp_ge_u32 s38, s34
  s_cselect_b32 s47, s35, 0
  s_add_u32 s39, s39, s47
  s_cmp_ge_u32 s38, s36
  s_cselect_b32 s47, s37, 0
  s_add_u32 s39, s39, s47
  s_mul_i32 s47, s39, 3072
  s_add_u32 s32, s32, 2
  s_and_b32 s32, s32, 255
  s_cmp_gt_u32 s44, 9
  s_cbranch_scc1 L_th35
  s_waitcnt vmcnt(4)
L_th35:
  buffer_load_dwordx4 v[112:115], v1, s[16:19], s47 offen offset:0 nt
  s_waitcnt lgkmcnt(0)
  v_and_b32 v28, v21, v4
  v_and_b32 v29, v21, v5
  v_and_b32 v30, v21, v6
  v_and_b32 v31, v21, v7
  ds_read_b32 v20, v38 offset:224
  s_waitcnt vmcnt(5)
  v_mfma_f32_32x32x16_bf16 v[80:95], v[28:31], v[188:191], v[80:95]
  s_waitcnt vmcnt(4)
  buffer_load_dwordx4 v[116:119], v1, s[16:19], s47 offen offset:1024 nt
  s_waitcnt lgkmcnt(0)
  v_and_b32 v24, v22, v4
  v_and_b32 v25, v22, v5
  v_and_b32 v26, v22, v6
  v_and_b32 v27, v22, v7
  ds_read_b32 v21, v39 offset:224
  s_waitcnt vmcnt(5)
  v_mfma_f32_32x32x16_bf16 v[96:111], v[24:27], v[192:195], v[96:111]
  s_cmp_gt_u32 s44, 10
  s_cbranch_scc1 L_th36
  s_waitcnt vmcnt(4)
L_th36:
  buffer_load_dwordx4 v[120:123], v1, s[16:19], s47 offen offset:2048 nt
  s_waitcnt lgkmcnt(0)
  v_and_b32 v28, v20, v4
  v_and_b32 v29, v20, v5
  v_and_b32 v30, v20, v6
  v_and_b32 v31, v20, v7
  ds_read_b32 v22, v38 offset:244
  s_waitcnt vmcnt(5)
  v_mfma_f32_32x32x16_bf16 v[64:79], v[28:31], v[196:199], v[64:79]
  s_and_b32 s38, s32, 31
  s_andn2_b32 s39, s32, 31
  s_lshl_b32 s39, s39, 1
  s_add_u32 s39, s39, s38
  s_add_u32 s39, s39, s33
  s_cmp_ge_u32 s38, s34
  s_cselect_b32 s47, s35, 0
  s_add_u32 s39, s39, s47
  s_cmp_ge_u32 s38, s36
  s_cselect_b32 s47, s37, 0
  s_add_u32 s39, s39, s47
  s_mul_i32 s47, s39, 3072
  s_add_u32 s32, s32, 2
  s_and_b32 s32, s32, 255
  s_waitcnt vmcnt(4)
  buffer_load_dwordx4 v[124:127], v1, s[16:19], s47 offen offset:0 nt
  s_waitcnt lgkmcnt(0)
  v_and_b32 v24, v21, v4
  v_and_b32 v25, v21, v5
  v_and_b32 v26, v21, v6
  v_and_b32 v27, v21, v7
  ds_read_b32 v20, v38 offset:256
  s_waitcnt vmcnt(5)
  v_mfma_f32_32x32x16_bf16 v[80:95], v[24:27], v[200:203], v[80:95]
  s_cmp_gt_u32 s44, 11
  s_cbranch_scc1 L_th37
  s_waitcnt vmcnt(4)
L_th37:
  buffer_load_dwordx4 v[128:131], v1, s[16:19], s47 offen offset:1024 nt
  s_waitcnt lgkmcnt(0)
  v_and_b32 v28, v22, v4
  v_and_b32 v29, v22, v5
  v_and_b32 v30, v22, v6
  v_and_b32 v31, v22, v7
  ds_read_b32 v21, v39 offset:256
  s_waitcnt vmcnt(5)
  v_mfma_f32_32x32x16_bf16 v[96:111], v[28:31], v[204:207], v[96:111]
  s_waitcnt vmcnt(4)
  buffer_load_dwordx4 v[132:135], v1, s[16:19], s47 offen offset:2048 nt
  v_add_u32 v38, 256, v38
  v_add_u32 v39, 256, v39
  s_mov_b32 s30, 12
L_loopV:
  s_waitcnt lgkmcnt(1)
  v_and_b32 v24, v20, v4
  v_and_b32 v25, v20, v5
  v_and_b32 v26, v20, v6
  v_and_b32 v27, v20, v7
  ds_read_b32 v22, v38 offset:20
  s_waitcnt vmcnt(5)
  v_mfma_f32_32x32x16_bf16 v[64:79], v[24:27], v[112:115], v[64:79]
  s_and_b32 s38, s32, 31
  s_andn2_b32 s39, s32, 31
  s_lshl_b32 s39, s39, 1
  s_add_u32 s39, s39, s38
  s_add_u32 s39, s39, s33
  s_cmp_ge_u32 s38, s34
  s_cselect_b32 s47, s35, 0
  s_add_u32 s39, s39, s47
  s_cmp_ge_u32 s38, s36
  s_cselect_b32 s47, s37, 0
  s_add_u32 s39, s39, s47
  s_mul_i32 s47, s39, 3072
  s_add_u32 s32, s32, 2
  s_and_b32 s32, s32, 255
  s_cmp_gt_u32 s44, 0
  s_cbranch_scc1 L_th38
  s_waitcnt vmcnt(4)
L_th38:
  buffer_load_dwordx4 v[136:139], v1, s[16:19], s47 offen offset:0 nt
  s_waitcnt lgkmcnt(1)
  v_and_b32 v28, v21, v4
  v_and_b32 v29, v21, v5
  v_and_b32 v30, v21, v6
  v_and_b32 v31, v21, v7
  ds_read_b32 v20, v38 offset:32
  s_waitcnt vmcnt(5)
  v_mfma_f32_32x32x16_bf16 v[80:95], v[28:31], v[116:119], v[80:95]
  s_waitcnt vmcnt(4)
  buffer_load_dwordx4 v[140:143], v1, s[16:19], s47 offen offset:1024 nt
  s_waitcnt lgkmcnt(1)
  v_and_b32 v24, v22, v4
  v_and_b32 v25, v22, v5
  v_and_b32 v26, v22, v6
  v_and_b32 v27, v22, v7
  ds_read_b32 v21, v39 offset:32
  s_waitcnt vmcnt(5)
  v_mfma_f32_32x32x16_bf16 v[96:111], v[24:27], v[120:123], v[96:111]
  s_cmp_gt_u32 s44, 1
  s_cbranch_scc1 L_th39
  s_waitcnt vmcnt(4)
L_th39:
  buffer_load_dwordx4 v[144:147], v1, s[16:19], s47 offen offset:2048 nt
  s_waitcnt lgkmcnt(1)
  v_and_b32 v28, v20, v4
  v_and_b32 v29, v20, v5
  v_and_b32 v30, v20, v6
  v_and_b32 v31, v20, v7
  ds_read_b32 v22, v38 offset:52
  s_waitcnt vmcnt(5)
  v_mfma_f32_32x32x16_bf16 v[64:79], v[28:31], v[124:127], v[64:79]
  s_and_b32 s38, s32, 31
  s_andn2_b32 s39, s32, 31
  s_lshl_b32 s39, s39, 1
  s_add_u32 s39, s39, s38
  s_add_u32 s39, s39, s33
  s_cmp_ge_u32 s38, s34
  s_cselect_b32 s47, s35, 0
  s_add_u32 s39, s39, s47
  s_cmp_ge_u32 s38, s36
  s_cselect_b32 s47, s37, 0
  s_add_u32 s39, s39, s47
  s_mul_i32 s47, s39, 3072
  s_add_u32 s32, s32, 2
  s_and_b32 s32, s32, 255
  s_waitcnt vmcnt(4)
  buffer_load_dwordx4 v[148:151], v1, s[16:19], s47 offen offset:0 nt
  s_waitcnt lgkmcnt(1)
  v_and_b32 v24, v21, v4
  v_and_b32 v25, v21, v5
  v_and_b32 v26, v21, v6
  v_and_b32 v27, v21, v7
  ds_read_b32 v20, v38 offset:64
  s_waitcnt vmcnt(5)
  v_mfma_f32_32x32x16_bf16 v[80:95], v[24:27], v[128:131], v[80:95]
  s_cmp_gt_u32 s44, 2
  s_cbranch_scc1 L_th40
  s_waitcnt vmcnt(4)
L_th40:
  buffer_load_dwordx4 v[152:155], v1, s[16:19], s47 offen offset:1024 nt
  s_waitcnt lgkmcnt(1)
  v_and_b32 v28, v22, v4
  v_and_b32 v29, v22, v5
  v_and_b32 v30, v22, v6
  v_and_b32 v31, v22, v7
  ds_read_b32 v21, v39 offset:64
  s_waitcnt vmcnt(5)
  v_mfma_f32_32x32x16_bf16 v[96:111], v[28:31], v[132:135], v[96:111]
  s_waitcnt vmcnt(4)
  buffer_load_dwordx4 v[156:159], v1, s[16:19], s47 offen offset:2048 nt
  s_waitcnt lgkmcnt(1)
  v_and_b32 v24, v20, v4
  v_and_b32 v25, v20, v5
  v_and_b32 v26, v20, v6
  v_and_b32 v27, v20, v7
  ds_read_b32 v22, v38 offset:84
  s_waitcnt vmcnt(5)
  v_mfma_f32_32x32x16_bf16 v[64:79], v[24:27], v[136:139], v[64:79]
  s_and_b32 s38, s32, 31
  s_andn2_b32 s39, s32, 31
  s_lshl_b32 s39, s39, 1
  s_add_u32 s39, s39, s38
  s_add_u32 s39, s39, s33
  s_cmp_ge_u32 s38, s34
  s_cselect_b32 s47, s35, 0
  s_add_u32 s39, s39, s47
  s_cmp_ge_u32 s38, s36
  s_cselect_b32 s47, s37, 0
  s_add_u32 s39, s39, s47
  s_mul_i32 s47, s39, 3072
  s_add_u32 s32, s32, 2
  s_and_b32 s32, s32, 255
  s_cmp_gt_u32 s44, 3
  s_cbranch_scc1 L_th41
  s_waitcnt vmcnt(4)
L_th41:
  buffer_load_dwordx4 v[160:163], v1, s[16:19], s47 offen offset:0 nt
  s_waitcnt lgkmcnt(1)
  v_and_b32 v28, v21, v4
  v_and_b32 v29, v21, v5
  v_and_b32 v30, v21, v6
  v_and_b32 v31, v21, v7
  ds_read_b32 v20, v38 offset:96
  s_waitcnt vmcnt(5)
  v_mfma_f32_32x32x16_bf16 v[80:95], v[28:31], v[140:143], v[80:95]
  s_waitcnt vmcnt(4)
  buffer_load_dwordx4 v[164:167], v1, s[16:19], s47 offen offset:1024 nt
  s_waitcnt lgkmcnt(1)
  v_and_b32 v24, v22, v4
  v_and_b32 v25, v22, v5
  v_and_b32 v26, v22, v6
  v_and_b32 v27, v22, v7
  ds_read_b32 v21, v39 offset:96
  s_waitcnt vmcnt(5)
  v_mfma_f32_32x32x16_bf16 v[96:111], v[24:27], v[144:147], v[96:111]
  s_cmp_gt_u32 s44, 4
  s_cbranch_scc1 L_th42
  s_waitcnt vmcnt(4)
L_th42:
  buffer_load_dwordx4 v[168:171], v1, s[16:19], s47 offen offset:2048 nt
  s_add_u32 s88, s88, 1
  v_mov_b32 v210, s88
  buffer_store_byte v210, v208, s[84:87], 0 offen
  buffer_load_ubyte v211, v209, s[84:87], 0 offen nt
  s_and_b32 s93, s88, 1
  s_cmp_eq_u32 s93, 0
  s_cselect_b32 s93, 0, 0x1000
  v_add_u32 v215, s93, v212
  buffer_load_dword v213, v215, s[84:87], 0 offen sc1
  s_waitcnt lgkmcnt(1)
  v_and_b32 v28, v20, v4
  v_and_b32 v29, v20, v5
  v_and_b32 v30, v20, v6
  v_and_b32 v31, v20, v7
  ds_read_b32 v22, v38 offset:116
  s_waitcnt vmcnt(8)
  v_mfma_f32_32x32x16_bf16 v[64:79], v[28:31], v[148:151], v[64:79]
  s_and_b32 s38, s32, 31
  s_andn2_b32 s39, s32, 31
  s_lshl_b32 s39, s39, 1
  s_add_u32 s39, s39, s38
  s_add_u32 s39, s39, s33
  s_cmp_ge_u32 s38, s34
  s_cselect_b32 s47, s35, 0
  s_add_u32 s39, s39, s47
  s_cmp_ge_u32 s38, s36
  s_cselect_b32 s47, s37, 0
  s_add_u32 s39, s39, s47
  s_mul_i32 s47, s39, 3072
  s_add_u32 s32, s32, 2
  s_and_b32 s32, s32, 255
  s_waitcnt vmcnt(7)
  buffer_load_dwordx4 v[172:175], v1, s[16:19], s47 offen offset:0 nt
  s_waitcnt lgkmcnt(1)
  v_and_b32 v24, v21, v4
  v_and_b32 v25, v21, v5
  v_and_b32 v26, v21, v6
  v_and_b32 v27, v21, v7
  ds_read_b32 v20, v38 offset:128
  s_waitcnt vmcnt(8)
  v_mfma_f32_32x32x16_bf16 v[80:95], v[24:27], v[152:155], v[80:95]
  s_cmp_gt_u32 s44, 5
  s_cbranch_scc1 L_th43
  s_waitcnt vmcnt(7)
L_th43:
  buffer_load_dwordx4 v[176:179], v1, s[16:19], s47 offen offset:1024 nt
  s_waitcnt lgkmcnt(1)
  v_and_b32 v28, v22, v4
  v_and_b32 v29, v22, v5
  v_and_b32 v30, v22, v6
  v_and_b32 v31, v22, v7
  ds_read_b32 v21, v39 offset:128
  s_waitcnt vmcnt(8)
  v_mfma_f32_32x32x16_bf16 v[96:111], v[28:31], v[156:159], v[96:111]
  s_waitcnt vmcnt(7)
  buffer_load_dwordx4 v[180:183], v1, s[16:19], s47 offen offset:2048 nt
  s_waitcnt lgkmcnt(1)
  v_and_b32 v24, v20, v4
  v_and_b32 v25, v20, v5
  v_and_b32 v26, v20, v6
  v_and_b32 v27, v20, v7
  ds_read_b32 v22, v38 offset:148
  s_waitcnt vmcnt(8)
  v_mfma_f32_32x32x16_bf16 v[64:79], v[24:27], v[160:163], v[64:79]
  s_and_b32 s38, s32, 31
  s_andn2_b32 s39, s32, 31
  s_lshl_b32 s39, s39, 1
  s_add_u32 s39, s39, s38
  s_add_u32 s39, s39, s33
  s_cmp_ge_u32 s38, s34
  s_cselect_b32 s47, s35, 0
  s_add_u32 s39, s39, s47
  s_cmp_ge_u32 s38, s36
  s_cselect_b32 s47, s37, 0
  s_add_u32 s39, s39, s47
  s_mul_i32 s47, s39, 3072
  s_add_u32 s32, s32, 2
  s_and_b32 s32, s32, 255
  s_cmp_gt_u32 s44, 6
  s_cbranch_scc1 L_th44
  s_waitcnt vmcnt(7)
L_th44:
  buffer_load_dwordx4 v[184:187], v1, s[16:19], s47 offen offset:0 nt
  s_waitcnt lgkmcnt(1)
  v_and_b32 v28, v21, v4
  v_and_b32 v29, v21, v5
  v_and_b32 v30, v21, v6
  v_and_b32 v31, v21, v7
  ds_read_b32 v20, v38 offset:160
  s_waitcnt vmcnt(8)
  v_mfma_f32_32x32x16_bf16 v[80:95], v[28:31], v[164:167], v[80:95]
  s_waitcnt vmcnt(7)
  buffer_load_dwordx4 v[188:191], v1, s[16:19], s47 offen offset:1024 nt
  s_waitcnt lgkmcnt(1)
  v_and_b32 v24, v22, v4
  v_and_b32 v25, v22, v5
  v_and_b32 v26, v22, v6
  v_and_b32 v27, v22, v7
  ds_read_b32 v21, v39 offset:160
  s_waitcnt vmcnt(8)
  v_mfma_f32_32x32x16_bf16 v[96:111], v[24:27], v[168:171], v[96:111]
  s_cmp_gt_u32 s44, 7
  s_cbranch_scc1 L_th45
  s_waitcnt vmcnt(4)
L_th45:
  buffer_load_dwordx4 v[192:195], v1, s[16:19], s47 offen offset:2048 nt
  s_waitcnt lgkmcnt(1)
  v_and_b32 v28, v20, v4
  v_and_b32 v29, v20, v5
  v_and_b32 v30, v20, v6
  v_and_b32 v31, v20, v7
  ds_read_b32 v22, v38 offset:180
  s_waitcnt vmcnt(5)
  v_mfma_f32_32x32x16_bf16 v[64:79], v[28:31], v[172:175], v[64:79]
  s_and_b32 s38, s32, 31
  s_andn2_b32 s39, s32, 31
  s_lshl_b32 s39, s39, 1
  s_add_u32 s39, s39, s38
  s_add_u32 s39, s39, s33
  s_cmp_ge_u32 s38, s34
  s_cselect_b32 s47, s35, 0
  s_add_u32 s39, s39, s47
  s_cmp_ge_u32 s38, s36
  s_cselect_b32 s47, s37, 0
  s_add_u32 s39, s39, s47
  s_mul_i32 s47, s39, 3072
  s_add_u32 s32, s32, 2
  s_and_b32 s32, s32, 255
  s_waitcnt vmcnt(4)
  buffer_load_dwordx4 v[196:199], v1, s[16:19], s47 offen offset:0 nt
  s_waitcnt lgkmcnt(1)
  v_and_b32 v24, v21, v4
  v_and_b32 v25, v21, v5
  v_and_b32 v26, v21, v6
  v_and_b32 v27, v21, v7
  ds_read_b32 v20, v38 offset:192
  s_waitcnt vmcnt(5)
  v_mfma_f32_32x32x16_bf16 v[80:95], v[24:27], v[176:179], v[80:95]
  s_cmp_gt_u32 s44, 8
  s_cbranch_scc1 L_th46
  s_waitcnt vmcnt(4)
L_th46:
  buffer_load_dwordx4 v[200:203], v1, s[16:19], s47 offen offset:1024 nt
  v_cmp_ge_u32 vcc, v211, v210
  s_nop 1
  s_bcnt1_i32_b64 s90, vcc
  s_sub_i32 s90, s90, 10
  s_max_i32 s90, s90, 0
  s_lshr_b32 s90, s90, 1
  s_cmp_lg_u32 s93, 0
  s_cbranch_scc1 L_ng47
  v_sad_u8 v213, v213, 0, 0
  s_nop 1
  v_add_u32_dpp v213, v213, v213 quad_perm:[1,0,3,2] row_mask:0xf bank_mask:0xf
  s_nop 1
  v_add_u32_dpp v213, v213, v213 quad_perm:[2,3,0,1] row_mask:0xf bank_mask:0xf
  s_nop 1
  v_add_u32_dpp v213, v213, v213 row_half_mirror row_mask:0xf bank_mask:0xf
  s_nop 1
  v_readlane_b32 s94, v213, s92
  v_add_u32_dpp v213, v213, v213 row_mirror row_mask:0xf bank_mask:0xf
  s_nop 0
  v_mov_b32 v214, v213
  s_nop 1
  v_permlane16_swap_b32 v213, v214
  s_nop 1
  v_add_u32 v213, v213, v214
  s_nop 0
  v_mov_b32 v214, v213
  s_nop 1
  v_permlane32_swap_b32 v213, v214
  s_nop 1
  v_add_u32 v213, v213, v214
  s_nop 0
  v_readfirstlane_b32 s91, v213
  s_lshr_b32 s91, s91, 3
  s_sub_i32 s91, s91, s94
  s_max_i32 s91, s91, 0
  s_mul_i32 s91, s91, 3
  s_lshr_b32 s91, s91, 2
  s_min_u32 s91, s91, 8
L_ng47:
  s_add_i32 s90, s90, s91
  s_add_i32 s44, s90, s89
  s_waitcnt lgkmcnt(1)
  v_and_b32 v28, v22, v4
  v_and_b32 v29, v22, v5
  v_and_b32 v30, v22, v6
  v_and_b32 v31, v22, v7
  ds_read_b32 v21, v39 offset:192
  s_waitcnt vmcnt(5)
  v_mfma_f32_32x32x16_bf16 v[96:111], v[28:31], v[180:183], v[96:111]
  s_waitcnt vmcnt(4)
  buffer_load_dwordx4 v[204:207], v1, s[16:19], s47 offen offset:2048 nt
  s_waitcnt lgkmcnt(1)
  v_and_b32 v24, v20, v4
  v_and_b32 v25, v20, v5
  v_and_b32 v26, v20, v6
  v_and_b32 v27, v20, v7
  ds_read_b32 v22, v38 offset:212
  s_waitcnt vmcnt(5)
  v_mfma_f32_32x32x16_bf16 v[64:79], v[24:27], v[184:187], v[64:79]
  s_and_b32 s38, s32, 31
  s_andn2_b32 s39, s32, 31
  s_lshl_b32 s39, s39, 1
  s_add_u32 s39, s39, s38
  s_add_u32 s39, s39, s33
  s_cmp_ge_u32 s38, s34
  s_cselect_b32 s47, s35, 0
  s_add_u32 s39, s39, s47
  s_cmp_ge_u32 s38, s36
  s_cselect_b32 s47, s37, 0
  s_add_u32 s39, s39, s47
  s_mul_i32 s47, s39, 3072
  s_add_u32 s32, s32, 2
  s_and_b32 s32, s32, 255
  s_cmp_gt_u32 s44, 9
  s_cbranch_scc1 L_th48
  s_waitcnt vmcnt(4)
L_th48:
  buffer_load_dwordx4 v[112:115], v1, s[16:19], s47 offen offset:0 nt
  s_waitcnt lgkmcnt(1)
  v_and_b32 v28, v21, v4
  v_and_b32 v29, v21, v5
  v_and_b32 v30, v21, v6
  v_and_b32 v31, v21, v7
  ds_read_b32 v20, v38 offset:224
  s_waitcnt vmcnt(5)
  v_mfma_f32_32x32x16_bf16 v[80:95], v[28:31], v[188:191], v[80:95]
  s_waitcnt vmcnt(4)
  buffer_load_dwordx4 v[116:119], v1, s[16:19], s47 offen offset:1024 nt
  s_waitcnt lgkmcnt(1)
  v_and_b32 v24, v22, v4
  v_and_b32 v25, v22, v5
  v_and_b32 v26, v22, v6
  v_and_b32 v27, v22, v7
  ds_read_b32 v21, v39 offset:224
  s_waitcnt vmcnt(5)
  v_mfma_f32_32x32x16_bf16 v[96:111], v[24:27], v[192:195], v[96:111]
  s_cmp_gt_u32 s44, 10
  s_cbranch_scc1 L_th49
  s_waitcnt vmcnt(4)
L_th49:
  buffer_load_dwordx4 v[120:123], v1, s[16:19], s47 offen offset:2048 nt
  s_waitcnt lgkmcnt(1)
  v_and_b32 v28, v20, v4
  v_and_b32 v29, v20, v5
  v_and_b32 v30, v20, v6
  v_and_b32 v31, v20, v7
  ds_read_b32 v22, v38 offset:244
  s_waitcnt vmcnt(5)
  v_mfma_f32_32x32x16_bf16 v[64:79], v[28:31], v[196:199], v[64:79]
  s_and_b32 s38, s32, 31
  s_andn2_b32 s39, s32, 31
  s_lshl_b32 s39, s39, 1
  s_add_u32 s39, s39, s38
  s_add_u32 s39, s39, s33
  s_cmp_ge_u32 s38, s34
  s_cselect_b32 s47, s35, 0
  s_add_u32 s39, s39, s47
  s_cmp_ge_u32 s38, s36
  s_cselect_b32 s47, s37, 0
  s_add_u32 s39, s39, s47
  s_mul_i32 s47, s39, 3072
  s_add_u32 s32, s32, 2
  s_and_b32 s32, s32, 255
  s_waitcnt vmcnt(4)
  buffer_load_dwordx4 v[124:127], v1, s[16:19], s47 offen offset:0 nt
  s_waitcnt lgkmcnt(1)
  v_and_b32 v24, v21, v4
  v_and_b32 v25, v21, v5
  v_and_b32 v26, v21, v6
  v_and_b32 v27, v21, v7
  ds_read_b32 v20, v38 offset:256
  s_waitcnt vmcnt(5)
  v_mfma_f32_32x32x16_bf16 v[80:95], v[24:27], v[200:203], v[80:95]
  s_cmp_gt_u32 s44, 11
  s_cbranch_scc1 L_th50
  s_waitcnt vmcnt(4)
L_th50:
  buffer_load_dwordx4 v[128:131], v1, s[16:19], s47 offen offset:1024 nt
  s_waitcnt lgkmcnt(1)
  v_and_b32 v28, v22, v4
  v_and_b32 v29, v22, v5
  v_and_b32 v30, v22, v6
  v_and_b32 v31, v22, v7
  ds_read_b32 v21, v39 offset:256
  s_waitcnt vmcnt(5)
  v_mfma_f32_32x32x16_bf16 v[96:111], v[28:31], v[204:207], v[96:111]
  s_waitcnt vmcnt(4)
  buffer_load_dwordx4 v[132:135], v1, s[16:19], s47 offen offset:2048 nt
  v_add_u32 v38, 256, v38
  v_add_u32 v39, 256, v39
  s_sub_u32 s30, s30, 1
  s_cmp_lg_u32 s30, 0
  s_cbranch_scc1 L_loopV
  s_waitcnt lgkmcnt(1)
  v_and_b32 v24, v20, v4
  v_and_b32 v25, v20, v5
  v_and_b32 v26, v20, v6
  v_and_b32 v27, v20, v7
  ds_read_b32 v22, v38 offset:20
  s_waitcnt vmcnt(5)
  v_mfma_f32_32x32x16_bf16 v[64:79], v[24:27], v[112:115], v[64:79]
  s_and_b32 s38, s32, 31
  s_andn2_b32 s39, s32, 31
  s_lshl_b32 s39, s39, 1
  s_add_u32 s39, s39, s38
  s_add_u32 s39, s39, s33
  s_cmp_ge_u32 s38, s34
  s_cselect_b32 s47, s35, 0
  s_add_u32 s39, s39, s47
  s_cmp_ge_u32 s38, s36
  s_cselect_b32 s47, s37, 0
  s_add_u32 s39, s39, s47
  s_mul_i32 s47, s39, 3072
  s_add_u32 s32, s32, 2
  s_and_b32 s32, s32, 255
  buffer_load_dwordx4 v[136:139], v1, s[16:19], s47 offen offset:0 nt
  s_waitcnt lgkmcnt(1)
  v_and_b32 v28, v21, v4
  v_and_b32 v29, v21, v5
  v_and_b32 v30, v21, v6
  v_and_b32 v31, v21, v7
  ds_read_b32 v20, v38 offset:32
  s_waitcnt vmcnt(5)
  v_mfma_f32_32x32x16_bf16 v[80:95], v[28:31], v[116:119], v[80:95]
  buffer_load_dwordx4 v[140:143], v1, s[16:19], s47 offen offset:1024 nt
  s_waitcnt lgkmcnt(1)
  v_and_b32 v24, v22, v4
  v_and_b32 v25, v22, v5
  v_and_b32 v26, v22, v6
  v_and_b32 v27, v22, v7
  ds_read_b32 v21, v39 offset:32
  s_waitcnt vmcnt(5)
  v_mfma_f32_32x32x16_bf16 v[96:111], v[24:27], v[120:123], v[96:111]
  buffer_load_dwordx4 v[144:147], v1, s[16:19], s47 offen offset:2048 nt
  s_waitcnt lgkmcnt(1)
  v_and_b32 v28, v20, v4
  v_and_b32 v29, v20, v5
  v_and_b32 v30, v20, v6
  v_and_b32 v31, v20, v7
  ds_read_b32 v22, v38 offset:52
  s_waitcnt vmcnt(5)
  v_mfma_f32_32x32x16_bf16 v[64:79], v[28:31], v[124:127], v[64:79]
  s_and_b32 s38, s32, 31
  s_andn2_b32 s39, s32, 31
  s_lshl_b32 s39, s39, 1
  s_add_u32 s39, s39, s38
  s_add_u32 s39, s39, s33
  s_cmp_ge_u32 s38, s34
  s_cselect_b32 s47, s35, 0
  s_add_u32 s39, s39, s47
  s_cmp_ge_u32 s38, s36
  s_cselect_b32 s47, s37, 0
  s_add_u32 s39, s39, s47
  s_mul_i32 s47, s39, 3072
  s_add_u32 s32, s32, 2
  s_and_b32 s32, s32, 255
  buffer_load_dwordx4 v[148:151], v1, s[16:19], s47 offen offset:0 nt
  s_waitcnt lgkmcnt(1)
  v_and_b32 v24, v21, v4
  v_and_b32 v25, v21, v5
  v_and_b32 v26, v21, v6
  v_and_b32 v27, v21, v7
  ds_read_b32 v20, v38 offset:64
  s_waitcnt vmcnt(5)
  v_mfma_f32_32x32x16_bf16 v[80:95], v[24:27], v[128:131], v[80:95]
  buffer_load_dwordx4 v[152:155], v1, s[16:19], s47 offen offset:1024 nt
  s_waitcnt lgkmcnt(1)
  v_and_b32 v28, v22, v4
  v_and_b32 v29, v22, v5
  v_and_b32 v30, v22, v6
  v_and_b32 v31, v22, v7
  ds_read_b32 v21, v39 offset:64
  s_waitcnt vmcnt(5)
  v_mfma_f32_32x32x16_bf16 v[96:111], v[28:31], v[132:135], v[96:111]
  buffer_load_dwordx4 v[156:159], v1, s[16:19], s47 offen offset:2048 nt
  s_waitcnt lgkmcnt(1)
  v_and_b32 v24, v20, v4
  v_and_b32 v25, v20, v5
  v_and_b32 v26, v20, v6
  v_and_b32 v27, v20, v7
  ds_read_b32 v22, v38 offset:84
  s_waitcnt vmcnt(5)
  v_mfma_f32_32x32x16_bf16 v[64:79], v[24:27], v[136:139], v[64:79]
  s_and_b32 s38, s32, 31
  s_andn2_b32 s39, s32, 31
  s_lshl_b32 s39, s39, 1
  s_add_u32 s39, s39, s38
  s_add_u32 s39, s39, s33
  s_cmp_ge_u32 s38, s34
  s_cselect_b32 s47, s35, 0
  s_add_u32 s39, s39, s47
  s_cmp_ge_u32 s38, s36
  s_cselect_b32 s47, s37, 0
  s_add_u32 s39, s39, s47
  s_mul_i32 s47, s39, 3072
  s_add_u32 s32, s32, 2
  s_and_b32 s32, s32, 255
  buffer_load_dwordx4 v[160:163], v1, s[16:19], s47 offen offset:0 nt
  s_waitcnt lgkmcnt(1)
  v_and_b32 v28, v21, v4
  v_and_b32 v29, v21, v5
  v_and_b32 v30, v21, v6
  v_and_b32 v31, v21, v7
  ds_read_b32 v20, v38 offset:96
  s_waitcnt vmcnt(5)
  v_mfma_f32_32x32x16_bf16 v[80:95], v[28:31], v[140:143], v[80:95]
  buffer_load_dwordx4 v[164:167], v1, s[16:19], s47 offen offset:1024 nt
  s_waitcnt lgkmcnt(1)
  v_and_b32 v24, v22, v4
  v_and_b32 v25, v22, v5
  v_and_b32 v26, v22, v6
  v_and_b32 v27, v22, v7
  ds_read_b32 v21, v39 offset:96
  s_waitcnt vmcnt(5)
  v_mfma_f32_32x32x16_bf16 v[96:111], v[24:27], v[144:147], v[96:111]
  buffer_load_dwordx4 v[168:171], v1, s[16:19], s47 offen offset:2048 nt
  s_waitcnt lgkmcnt(1)
  v_and_b32 v28, v20, v4
  v_and_b32 v29, v20, v5
  v_and_b32 v30, v20, v6
  v_and_b32 v31, v20, v7
  ds_read_b32 v22, v38 offset:116
  s_waitcnt vmcnt(5)
  v_mfma_f32_32x32x16_bf16 v[64:79], v[28:31], v[148:151], v[64:79]
  s_and_b32 s38, s32, 31
  s_andn2_b32 s39, s32, 31
  s_lshl_b32 s39, s39, 1
  s_add_u32 s39, s39, s38
  s_add_u32 s39, s39, s33
  s_cmp_ge_u32 s38, s34
  s_cselect_b32 s47, s35, 0
  s_add_u32 s39, s39, s47
  s_cmp_ge_u32 s38, s36
  s_cselect_b32 s47, s37, 0
  s_add_u32 s39, s39, s47
  s_mul_i32 s47, s39, 3072
  s_add_u32 s32, s32, 2
  s_and_b32 s32, s32, 255
  buffer_load_dwordx4 v[172:175], v1, s[16:19], s47 offen offset:0 nt
  s_waitcnt lgkmcnt(1)
  v_and_b32 v24, v21, v4
  v_and_b32 v25, v21, v5
  v_and_b32 v26, v21, v6
  v_and_b32 v27, v21, v7
  ds_read_b32 v20, v38 offset:128
  s_waitcnt vmcnt(5)
  v_mfma_f32_32x32x16_bf16 v[80:95], v[24:27], v[152:155], v[80:95]
  buffer_load_dwordx4 v[176:179], v1, s[16:19], s47 offen offset:1024 nt
  s_waitcnt lgkmcnt(1)
  v_and_b32 v28, v22, v4
  v_and_b32 v29, v22, v5
  v_and_b32 v30, v22, v6
  v_and_b32 v31, v22, v7
  ds_read_b32 v21, v39 offset:128
  s_waitcnt vmcnt(5)
  v_mfma_f32_32x32x16_bf16 v[96:111], v[28:31], v[156:159], v[96:111]
  buffer_load_dwordx4 v[180:183], v1, s[16:19], s47 offen offset:2048 nt
  s_waitcnt lgkmcnt(1)
  v_and_b32 v24, v20, v4
  v_and_b32 v25, v20, v5
  v_and_b32 v26, v20, v6
  v_and_b32 v27, v20, v7
  ds_read_b32 v22, v38 offset:148
  s_waitcnt vmcnt(5)
  v_mfma_f32_32x32x16_bf16 v[64:79], v[24:27], v[160:163], v[64:79]
  s_and_b32 s38, s32, 31
  s_andn2_b32 s39, s32, 31
  s_lshl_b32 s39, s39, 1
  s_add_u32 s39, s39, s38
  s_add_u32 s39, s39, s33
  s_cmp_ge_u32 s38, s34
  s_cselect_b32 s47, s35, 0
  s_add_u32 s39, s39, s47
  s_cmp_ge_u32 s38, s36
  s_cselect_b32 s47, s37, 0
  s_add_u32 s39, s39, s47
  s_mul_i32 s47, s39, 3072
  s_add_u32 s32, s32, 2
  s_and_b32 s32, s32, 255
  buffer_load_dwordx4 v[184:187], v1, s[16:19], s47 offen offset:0 nt
  buffer_load_dwordx4 v[188:191], v1, s[16:19], s47 offen offset:1024 nt
  s_waitcnt lgkmcnt(1)
  v_and_b32 v28, v21, v4
  v_and_b32 v29, v21, v5
  v_and_b32 v30, v21, v6
  v_and_b32 v31, v21, v7
  ds_read_b32 v20, v38 offset:160
  s_waitcnt vmcnt(6)
  v_mfma_f32_32x32x16_bf16 v[80:95], v[28:31], v[164:167], v[80:95]
  buffer_load_dwordx4 v[192:195], v1, s[16:19], s47 offen offset:2048 nt
  s_and_b32 s38, s32, 31
  s_andn2_b32 s39, s32, 31
  s_lshl_b32 s39, s39, 1
  s_add_u32 s39, s39, s38
  s_add_u32 s39, s39, s33
  s_cmp_ge_u32 s38, s34
  s_cselect_b32 s47, s35, 0
  s_add_u32 s39, s39, s47
  s_cmp_ge_u32 s38, s36
  s_cselect_b32 s47, s37, 0
  s_add_u32 s39, s39, s47
  s_mul_i32 s47, s39, 3072
  s_add_u32 s32, s32, 2
  s_and_b32 s32, s32, 255
  buffer_load_dwordx4 v[196:199], v1, s[16:19], s47 offen offset:0 nt
  s_waitcnt lgkmcnt(1)
  v_and_b32 v24, v22, v4
  v_and_b32 v25, v22, v5
  v_and_b32 v26, v22, v6
  v_and_b32 v27, v22, v7
  ds_read_b32 v21, v39 offset:160
  s_waitcnt vmcnt(7)
  v_mfma_f32_32x32x16_bf16 v[96:111], v[24:27], v[168:171], v[96:111]
  buffer_load_dwordx4 v[200:203], v1, s[16:19], s47 offen offset:1024 nt
  buffer_load_dwordx4 v[204:207], v1, s[16:19], s47 offen offset:2048 nt
  s_waitcnt lgkmcnt(1)
  v_and_b32 v28, v20, v4
  v_and_b32 v29, v20, v5
  v_and_b32 v30, v20, v6
  v_and_b32 v31, v20, v7
  ds_read_b32 v22, v38 offset:180
  s_waitcnt vmcnt(8)
  v_mfma_f32_32x32x16_bf16 v[64:79], v[28:31], v[172:175], v[64:79]
  s_and_b32 s38, s32, 31
  s_andn2_b32 s39, s32, 31
  s_lshl_b32 s39, s39, 1
  s_add_u32 s39, s39, s38
  s_add_u32 s39, s39, s33
  s_cmp_ge_u32 s38, s34
  s_cselect_b32 s47, s35, 0
  s_add_u32 s39, s39, s47
  s_cmp_ge_u32 s38, s36
  s_cselect_b32 s47, s37, 0
  s_add_u32 s39, s39, s47
  s_mul_i32 s47, s39, 3072
  s_add_u32 s32, s32, 2
  s_and_b32 s32, s32, 255
  buffer_load_dwordx4 v[112:115], v1, s[16:19], s47 offen offset:0 nt
  buffer_load_dwordx4 v[116:119], v1, s[16:19], s47 offen offset:1024 nt
  s_waitcnt lgkmcnt(1)
  v_and_b32 v24, v21, v4
  v_and_b32 v25, v21, v5
  v_and_b32 v26, v21, v6
  v_and_b32 v27, v21, v7
  ds_read_b32 v20, v38 offset:192
  s_waitcnt vmcnt(9)
  v_mfma_f32_32x32x16_bf16 v[80:95], v[24:27], v[176:179], v[80:95]
  buffer_load_dwordx4 v[120:123], v1, s[16:19], s47 offen offset:2048 nt
  s_and_b32 s38, s32, 31
  s_andn2_b32 s39, s32, 31
  s_lshl_b32 s39, s39, 1
  s_add_u32 s39, s39, s38
  s_add_u32 s39, s39, s33
  s_cmp_ge_u32 s38, s34
  s_cselect_b32 s47, s35, 0
  s_add_u32 s39, s39, s47
  s_cmp_ge_u32 s38, s36
  s_cselect_b32 s47, s37, 0
  s_add_u32 s39, s39, s47
  s_mul_i32 s47, s39, 3072
  s_add_u32 s32, s32, 2
  s_and_b32 s32, s32, 255
  buffer_load_dwordx4 v[124:127], v1, s[16:19], s47 offen offset:0 nt
  s_waitcnt lgkmcnt(1)
  v_and_b32 v28, v22, v4
  v_and_b32 v29, v22, v5
  v_and_b32 v30, v22, v6
  v_and_b32 v31, v22, v7
  ds_read_b32 v21, v39 offset:192
  s_waitcnt vmcnt(10)
  v_mfma_f32_32x32x16_bf16 v[96:111], v[28:31], v[180:183], v[96:111]
  buffer_load_dwordx4 v[128:131], v1, s[16:19], s47 offen offset:1024 nt
  buffer_load_dwordx4 v[132:135], v1, s[16:19], s47 offen offset:2048 nt
  s_waitcnt lgkmcnt(1)
  v_and_b32 v24, v20, v4
  v_and_b32 v25, v20, v5
  v_and_b32 v26, v20, v6
  v_and_b32 v27, v20, v7
  ds_read_b32 v22, v38 offset:212
  s_waitcnt vmcnt(11)
  v_mfma_f32_32x32x16_bf16 v[64:79], v[24:27], v[184:187], v[64:79]
  s_and_b32 s38, s32, 31
  s_andn2_b32 s39, s32, 31
  s_lshl_b32 s39, s39, 1
  s_add_u32 s39, s39, s38
  s_add_u32 s39, s39, s33
  s_cmp_ge_u32 s38, s34
  s_cselect_b32 s47, s35, 0
  s_add_u32 s39, s39, s47
  s_cmp_ge_u32 s38, s36
  s_cselect_b32 s47, s37, 0
  s_add_u32 s39, s39, s47
  s_mul_i32 s47, s39, 3072
  s_add_u32 s32, s32, 2
  s_and_b32 s32, s32, 255
  buffer_load_dwordx4 v[136:139], v1, s[16:19], s47 offen offset:0 nt
  buffer_load_dwordx4 v[140:143], v1, s[16:19], s47 offen offset:1024 nt
  s_waitcnt lgkmcnt(1)
  v_and_b32 v28, v21, v4
  v_and_b32 v29, v21, v5
  v_and_b32 v30, v21, v6
  v_and_b32 v31, v21, v7
  ds_read_b32 v20, v38 offset:224
  s_waitcnt vmcnt(12)
  v_mfma_f32_32x32x16_bf16 v[80:95], v[28:31], v[188:191], v[80:95]
  buffer_load_dwordx4 v[144:147], v1, s[16:19], s47 offen offset:2048 nt
  s_and_b32 s38, s32, 31
  s_andn2_b32 s39, s32, 31
  s_lshl_b32 s39, s39, 1
  s_add_u32 s39, s39, s38
  s_add_u32 s39, s39, s33
  s_cmp_ge_u32 s38, s34
  s_cselect_b32 s47, s35, 0
  s_add_u32 s39, s39, s47
  s_cmp_ge_u32 s38, s36
  s_cselect_b32 s47, s37, 0
  s_add_u32 s39, s39, s47
  s_mul_i32 s47, s39, 3072
  s_add_u32 s32, s32, 2
  s_and_b32 s32, s32, 255
  buffer_load_dwordx4 v[148:151], v1, s[16:19], s47 offen offset:0 nt
  s_waitcnt lgkmcnt(1)
  v_and_b32 v24, v22, v4
  v_and_b32 v25, v22, v5
  v_and_b32 v26, v22, v6
  v_and_b32 v27, v22, v7
  ds_read_b32 v21, v39 offset:224
  s_waitcnt vmcnt(13)
  v_mfma_f32_32x32x16_bf16 v[96:111], v[24:27], v[192:195], v[96:111]
  buffer_load_dwordx4 v[152:155], v1, s[16:19], s47 offen offset:1024 nt
  buffer_load_dwordx4 v[156:159], v1, s[16:19], s47 offen offset:2048 nt
  s_waitcnt lgkmcnt(1)
  v_and_b32 v28, v20, v4
  v_and_b32 v29, v20, v5
  v_and_b32 v30, v20, v6
  v_and_b32 v31, v20, v7
  ds_read_b32 v22, v38 offset:244
  s_waitcnt vmcnt(14)
  v_mfma_f32_32x32x16_bf16 v[64:79], v[28:31], v[196:199], v[64:79]
  s_and_b32 s38, s32, 31
  s_andn2_b32 s39, s32, 31
  s_lshl_b32 s39, s39, 1
  s_add_u32 s39, s39, s38
  s_add_u32 s39, s39, s33
  s_cmp_ge_u32 s38, s34
  s_cselect_b32 s47, s35, 0
  s_add_u32 s39, s39, s47
  s_cmp_ge_u32 s38, s36
  s_cselect_b32 s47, s37, 0
  s_add_u32 s39, s39, s47
  s_mul_i32 s47, s39, 3072
  s_add_u32 s32, s32, 2
  s_and_b32 s32, s32, 255
  buffer_load_dwordx4 v[160:163], v1, s[16:19], s47 offen offset:0 nt
  buffer_load_dwordx4 v[164:167], v1, s[16:19], s47 offen offset:1024 nt
  s_waitcnt lgkmcnt(1)
  v_and_b32 v24, v21, v4
  v_and_b32 v25, v21, v5
  v_and_b32 v26, v21, v6
  v_and_b32 v27, v21, v7
  ds_read_b32 v20, v38 offset:256
  s_waitcnt vmcnt(15)
  v_mfma_f32_32x32x16_bf16 v[80:95], v[24:27], v[200:203], v[80:95]
  buffer_load_dwordx4 v[168:171], v1, s[16:19], s47 offen offset:2048 nt
  s_and_b32 s38, s32, 31
  s_andn2_b32 s39, s32, 31
  s_lshl_b32 s39, s39, 1
  s_add_u32 s39, s39, s38
  s_add_u32 s39, s39, s33
  s_cmp_ge_u32 s38, s34
  s_cselect_b32 s47, s35, 0
  s_add_u32 s39, s39, s47
  s_cmp_ge_u32 s38, s36
  s_cselect_b32 s47, s37, 0
  s_add_u32 s39, s39, s47
  s_mul_i32 s47, s39, 3072
  s_add_u32 s32, s32, 2
  s_and_b32 s32, s32, 255
  buffer_load_dwordx4 v[172:175], v1, s[16:19], s47 offen offset:0 nt
  s_waitcnt lgkmcnt(1)
  v_and_b32 v28, v22, v4
  v_and_b32 v29, v22, v5
  v_and_b32 v30, v22, v6
  v_and_b32 v31, v22, v7
  ds_read_b32 v21, v39 offset:256
  s_waitcnt vmcnt(16)
  v_mfma_f32_32x32x16_bf16 v[96:111], v[28:31], v[204:207], v[96:111]
  buffer_load_dwordx4 v[176:179], v1, s[16:19], s47 offen offset:1024 nt
  buffer_load_dwordx4 v[180:183], v1, s[16:19], s47 offen offset:2048 nt
  v_add_u32 v38, 256, v38
  v_add_u32 v39, 256, v39
  s_waitcnt lgkmcnt(1)
  v_and_b32 v24, v20, v4
  v_and_b32 v25, v20, v5
  v_and_b32 v26, v20, v6
  v_and_b32 v27, v20, v7
  ds_read_b32 v22, v38 offset:20
  s_waitcnt vmcnt(17)
  v_mfma_f32_32x32x16_bf16 v[64:79], v[24:27], v[112:115], v[64:79]
  s_and_b32 s38, s32, 31
  s_andn2_b32 s39, s32, 31
  s_lshl_b32 s39, s39, 1
  s_add_u32 s39, s39, s38
  s_add_u32 s39, s39, s33
  s_cmp_ge_u32 s38, s34
  s_cselect_b32 s47, s35, 0
  s_add_u32 s39, s39, s47
  s_cmp_ge_u32 s38, s36
  s_cselect_b32 s47, s37, 0
  s_add_u32 s39, s39, s47
  s_mul_i32 s47, s39, 3072
  s_add_u32 s32, s32, 2
  s_and_b32 s32, s32, 255
  buffer_load_dwordx4 v[184:187], v1, s[16:19], s47 offen offset:0 nt
  s_waitcnt lgkmcnt(1)
  v_and_b32 v28, v21, v4
  v_and_b32 v29, v21, v5
  v_and_b32 v30, v21, v6
  v_and_b32 v31, v21, v7
  ds_read_b32 v20, v38 offset:32
  s_waitcnt vmcnt(17)
  v_mfma_f32_32x32x16_bf16 v[80:95], v[28:31], v[116:119], v[80:95]
  buffer_load_dwordx4 v[188:191], v1, s[16:19], s47 offen offset:1024 nt
  s_waitcnt lgkmcnt(1)
  v_and_b32 v24, v22, v4
  v_and_b32 v25, v22, v5
  v_and_b32 v26, v22, v6
  v_and_b32 v27, v22, v7
  ds_read_b32 v21, v39 offset:32
  s_waitcnt vmcnt(17)
  v_mfma_f32_32x32x16_bf16 v[96:111], v[24:27], v[120:123], v[96:111]
  buffer_load_dwordx4 v[192:195], v1, s[16:19], s47 offen offset:2048 nt
  s_waitcnt lgkmcnt(1)
  v_and_b32 v28, v20, v4
  v_and_b32 v29, v20, v5
  v_and_b32 v30, v20, v6
  v_and_b32 v31, v20, v7
  ds_read_b32 v22, v38 offset:52
  s_waitcnt vmcnt(17)
  v_mfma_f32_32x32x16_bf16 v[64:79], v[28:31], v[124:127], v[64:79]
  s_and_b32 s38, s32, 31
  s_andn2_b32 s39, s32, 31
  s_lshl_b32 s39, s39, 1
  s_add_u32 s39, s39, s38
  s_add_u32 s39, s39, s33
  s_cmp_ge_u32 s38, s34
  s_cselect_b32 s47, s35, 0
  s_add_u32 s39, s39, s47
  s_cmp_ge_u32 s38, s36
  s_cselect_b32 s47, s37, 0
  s_add_u32 s39, s39, s47
  s_mul_i32 s47, s39, 3072
  s_add_u32 s32, s32, 2
  s_and_b32 s32, s32, 255
  buffer_load_dwordx4 v[196:199], v1, s[16:19], s47 offen offset:0 nt
  s_waitcnt lgkmcnt(1)
  v_and_b32 v24, v21, v4
  v_and_b32 v25, v21, v5
  v_and_b32 v26, v21, v6
  v_and_b32 v27, v21, v7
  ds_read_b32 v20, v38 offset:64
  s_waitcnt vmcnt(17)
  v_mfma_f32_32x32x16_bf16 v[80:95], v[24:27], v[128:131], v[80:95]
  buffer_load_dwordx4 v[200:203], v1, s[16:19], s47 offen offset:1024 nt
  s_waitcnt lgkmcnt(1)
  v_and_b32 v28, v22, v4
  v_and_b32 v29, v22, v5
  v_and_b32 v30, v22, v6
  v_and_b32 v31, v22, v7
  ds_read_b32 v21, v39 offset:64
  s_waitcnt vmcnt(17)
  v_mfma_f32_32x32x16_bf16 v[96:111], v[28:31], v[132:135], v[96:111]
  buffer_load_dwordx4 v[204:207], v1, s[16:19], s47 offen offset:2048 nt
  s_waitcnt lgkmcnt(1)
  v_and_b32 v24, v20, v4
  v_and_b32 v25, v20, v5
  v_and_b32 v26, v20, v6
  v_and_b32 v27, v20, v7
  ds_read_b32 v22, v38 offset:84
  s_waitcnt vmcnt(17)
  v_mfma_f32_32x32x16_bf16 v[64:79], v[24:27], v[136:139], v[64:79]
  s_waitcnt lgkmcnt(1)
  v_and_b32 v28, v21, v4
  v_and_b32 v29, v21, v5
  v_and_b32 v30, v21, v6
  v_and_b32 v31, v21, v7
  ds_read_b32 v20, v38 offset:96
  s_waitcnt vmcnt(16)
  v_mfma_f32_32x32x16_bf16 v[80:95], v[28:31], v[140:143], v[80:95]
  s_waitcnt lgkmcnt(1)
  v_and_b32 v24, v22, v4
  v_and_b32 v25, v22, v5
  v_and_b32 v26, v22, v6
  v_and_b32 v27, v22, v7
  ds_read_b32 v21, v39 offset:96
  s_waitcnt vmcnt(15)
  v_mfma_f32_32x32x16_bf16 v[96:111], v[24:27], v[144:147], v[96:111]
  s_waitcnt lgkmcnt(1)
  v_and_b32 v28, v20, v4
  v_and_b32 v29, v20, v5
  v_and_b32 v30, v20, v6
  v_and_b32 v31, v20, v7
  ds_read_b32 v22, v38 offset:116
  s_waitcnt vmcnt(14)
  v_mfma_f32_32x32x16_bf16 v[64:79], v[28:31], v[148:151], v[64:79]
  s_waitcnt lgkmcnt(1)
  v_and_b32 v24, v21, v4
  v_and_b32 v25, v21, v5
  v_and_b32 v26, v21, v6
  v_and_b32 v27, v21, v7
  ds_read_b32 v20, v38 offset:128
  s_waitcnt vmcnt(13)
  v_mfma_f32_32x32x16_bf16 v[80:95], v[24:27], v[152:155], v[80:95]
  s_waitcnt lgkmcnt(1)
  v_and_b32 v28, v22, v4
  v_and_b32 v29, v22, v5
  v_and_b32 v30, v22, v6
  v_and_b32 v31, v22, v7
  ds_read_b32 v21, v39 offset:128
  s_waitcnt vmcnt(12)
  v_mfma_f32_32x32x16_bf16 v[96:111], v[28:31], v[156:159], v[96:111]
  s_waitcnt lgkmcnt(1)
  v_and_b32 v24, v20, v4
  v_and_b32 v25, v20, v5
  v_and_b32 v26, v20, v6
  v_and_b32 v27, v20, v7
  ds_read_b32 v22, v38 offset:148
  s_waitcnt vmcnt(11)
  v_mfma_f32_32x32x16_bf16 v[64:79], v[24:27], v[160:163], v[64:79]
  s_waitcnt lgkmcnt(1)
  v_and_b32 v28, v21, v4
  v_and_b32 v29, v21, v5
  v_and_b32 v30, v21, v6
  v_and_b32 v31, v21, v7
  ds_read_b32 v20, v38 offset:160
  s_waitcnt vmcnt(10)
  v_mfma_f32_32x32x16_bf16 v[80:95], v[28:31], v[164:167], v[80:95]
  s_waitcnt lgkmcnt(1)
  v_and_b32 v24, v22, v4
  v_and_b32 v25, v22, v5
  v_and_b32 v26, v22, v6
  v_and_b32 v27, v22, v7
  ds_read_b32 v21, v39 offset:160
  s_waitcnt vmcnt(9)
  v_mfma_f32_32x32x16_bf16 v[96:111], v[24:27], v[168:171], v[96:111]
  s_waitcnt lgkmcnt(1)
  v_and_b32 v28, v20, v4
  v_and_b32 v29, v20, v5
  v_and_b32 v30, v20, v6
  v_and_b32 v31, v20, v7
  ds_read_b32 v22, v38 offset:180
  s_waitcnt vmcnt(8)
  v_mfma_f32_32x32x16_bf16 v[64:79], v[28:31], v[172:175], v[64:79]
  s_waitcnt lgkmcnt(1)
  v_and_b32 v24, v21, v4
  v_and_b32 v25, v21, v5
  v_and_b32 v26, v21, v6
  v_and_b32 v27, v21, v7
  ds_read_b32 v20, v38 offset:192
  s_waitcnt vmcnt(7)
  v_mfma_f32_32x32x16_bf16 v[80:95], v[24:27], v[176:179], v[80:95]
  s_waitcnt lgkmcnt(1)
  v_and_b32 v28, v22, v4
  v_and_b32 v29, v22, v5
  v_and_b32 v30, v22, v6
  v_and_b32 v31, v22, v7
  ds_read_b32 v21, v39 offset:192
  s_waitcnt vmcnt(6)
  v_mfma_f32_32x32x16_bf16 v[96:111], v[28:31], v[180:183], v[96:111]
  s_waitcnt lgkmcnt(1)
  v_and_b32 v24, v20, v4
  v_and_b32 v25, v20, v5
  v_and_b32 v26, v20, v6
  v_and_b32 v27, v20, v7
  ds_read_b32 v22, v38 offset:212
  s_waitcnt vmcnt(5)
  v_mfma_f32_32x32x16_bf16 v[64:79], v[24:27], v[184:187], v[64:79]
  s_waitcnt lgkmcnt(1)
  v_and_b32 v28, v21, v4
  v_and_b32 v29, v21, v5
  v_and_b32 v30, v21, v6
  v_and_b32 v31, v21, v7
  ds_read_b32 v20, v38 offset:224
  s_waitcnt vmcnt(4)
  v_mfma_f32_32x32x16_bf16 v[80:95], v[28:31], v[188:191], v[80:95]
  s_waitcnt lgkmcnt(1)
  v_and_b32 v24, v22, v4
  v_and_b32 v25, v22, v5
  v_and_b32 v26, v22, v6
  v_and_b32 v27, v22, v7
  ds_read_b32 v21, v39 offset:224
  s_waitcnt vmcnt(3)
  v_mfma_f32_32x32x16_bf16 v[96:111], v[24:27], v[192:195], v[96:111]
  s_waitcnt lgkmcnt(1)
  v_and_b32 v28, v20, v4
  v_and_b32 v29, v20, v5
  v_and_b32 v30, v20, v6
  v_and_b32 v31, v20, v7
  ds_read_b32 v22, v38 offset:244
  s_waitcnt vmcnt(2)
  v_mfma_f32_32x32x16_bf16 v[64:79], v[28:31], v[196:199], v[64:79]
  s_waitcnt lgkmcnt(1)
  v_and_b32 v24, v21, v4
  v_and_b32 v25, v21, v5
  v_and_b32 v26, v21, v6
  v_and_b32 v27, v21, v7
  s_waitcnt vmcnt(1)
  s_nop 0
  v_mfma_f32_32x32x16_bf16 v[80:95], v[24:27], v[200:203], v[80:95]
  s_waitcnt lgkmcnt(0)
  v_and_b32 v28, v22, v4
  v_and_b32 v29, v22, v5
  v_and_b32 v30, v22, v6
  v_and_b32 v31, v22, v7
  s_waitcnt vmcnt(0)
  s_nop 0
  v_mfma_f32_32x32x16_bf16 v[96:111], v[28:31], v[204:207], v[96:111]
  s_nop 4
  v_add_f32 v64, v64, v88
  v_add_f32 v65, v65, v89
  v_add_f32 v66, v66, v90
  v_add_f32 v67, v67, v91
  v_add_f32 v68, v68, v92
  v_add_f32 v69, v69, v93
  v_add_f32 v70, v70, v94
  v_add_f32 v71, v71, v95
  v_cndmask_b32 v48, v64, v68, s[64:65]
  v_cndmask_b32 v49, v65, v69, s[64:65]
  v_cndmask_b32 v50, v66, v70, s[64:65]
  v_cndmask_b32 v51, v67, v71, s[64:65]
  ds_write_b128 v40, v[48:51] offset:4096
  v_add_f32 v72, v72, v96
  v_add_f32 v73, v73, v97
  v_add_f32 v74, v74, v98
  v_add_f32 v75, v75, v99
  v_add_f32 v76, v76, v100
  v_add_f32 v77, v77, v101
  v_add_f32 v78, v78, v102
  v_add_f32 v79, v79, v103
  v_cndmask_b32 v52, v72, v76, s[66:67]
  v_cndmask_b32 v53, v73, v77, s[66:67]
  v_cndmask_b32 v54, v74, v78, s[66:67]
  v_cndmask_b32 v55, v75, v79, s[66:67]
  ds_write_b128 v41, v[52:55] offset:4096
  v_add_f32 v80, v80, v104
  v_add_f32 v81, v81, v105
  v_add_f32 v82, v82, v106
  v_add_f32 v83, v83, v107
  v_add_f32 v84, v84, v108
  v_add_f32 v85, v85, v109
  v_add_f32 v86, v86, v110
  v_add_f32 v87, v87, v111
  v_cndmask_b32 v56, v80, v84, s[68:69]
  v_cndmask_b32 v57, v81, v85, s[68:69]
  v_cndmask_b32 v58, v82, v86, s[68:69]
  v_cndmask_b32 v59, v83, v87, s[68:69]
  ds_write_b128 v42, v[56:59] offset:4096
  s_waitcnt lgkmcnt(0)
  s_barrier
  s_cmp_ge_u32 s48, 2
  s_cbranch_scc1 L_done
  ds_read_b64 v[112:113], v43 offset:4096
  ds_read_b64 v[114:115], v43 offset:4864
  ds_read_b64 v[116:117], v43 offset:5632
  ds_read_b64 v[118:119], v43 offset:6400
  ds_read_b64 v[120:121], v43 offset:16384
  ds_read_b64 v[122:123], v43 offset:17152
  ds_read_b64 v[124:125], v43 offset:17920
  ds_read_b64 v[126:127], v43 offset:18688
  ds_read_b64 v[128:129], v43 offset:28672
  ds_read_b64 v[130:131], v43 offset:29440
  ds_read_b64 v[132:133], v43 offset:30208
  ds_read_b64 v[134:135], v43 offset:30976
  ds_read_b64 v[136:137], v43 offset:40960
  ds_read_b64 v[138:139], v43 offset:41728
  ds_read_b64 v[140:141], v43 offset:42496
  ds_read_b64 v[142:143], v43 offset:43264
  s_waitcnt lgkmcnt(15)
  v_mul_f32 v48, s40, v112
  v_mul_f32 v49, s40, v113
  s_waitcnt lgkmcnt(14)
  v_mul_f32 v50, s40, v114
  v_mul_f32 v51, s40, v115
  s_waitcnt lgkmcnt(13)
  v_fmac_f32 v48, s40, v116
  v_fmac_f32 v49, s40, v117
  s_waitcnt lgkmcnt(12)
  v_fmac_f32 v50, s40, v118
  v_fmac_f32 v51, s40, v119
  s_waitcnt lgkmcnt(11)
  v_fmac_f32 v48, s41, v120
  v_fmac_f32 v49, s41, v121
  s_waitcnt lgkmcnt(10)
  v_fmac_f32 v50, s41, v122
  v_fmac_f32 v51, s41, v123
  s_waitcnt lgkmcnt(9)
  v_fmac_f32 v48, s41, v124
  v_fmac_f32 v49, s41, v125
  s_waitcnt lgkmcnt(8)
  v_fmac_f32 v50, s41, v126
  v_fmac_f32 v51, s41, v127
  s_waitcnt lgkmcnt(7)
  v_fmac_f32 v48, s42, v128
  v_fmac_f32 v49, s42, v129
  s_waitcnt lgkmcnt(6)
  v_fmac_f32 v50, s42, v130
  v_fmac_f32 v51, s42, v131
  s_waitcnt lgkmcnt(5)
  v_fmac_f32 v48, s42, v132
  v_fmac_f32 v49, s42, v133
  s_waitcnt lgkmcnt(4)
  v_fmac_f32 v50, s42, v134
  v_fmac_f32 v51, s42, v135
  s_waitcnt lgkmcnt(3)
  v_fmac_f32 v48, s43, v136
  v_fmac_f32 v49, s43, v137
  s_waitcnt lgkmcnt(2)
  v_fmac_f32 v50, s43, v138
  v_fmac_f32 v51, s43, v139
  s_waitcnt lgkmcnt(1)
  v_fmac_f32 v48, s43, v140
  v_fmac_f32 v49, s43, v141
  s_waitcnt lgkmcnt(0)
  v_fmac_f32 v50, s43, v142
  v_fmac_f32 v51, s43, v143
  v_add_f32 v46, v48, v50
  v_add_f32 v47, v49, v51
  v_cvt_pk_bf16_f32 v46, v46, v47
  buffer_store_dword v46, v45, s[24:27], 0 offen
L_done:
  s_endpgm
.section .rodata,"a"
.p2align 6
.amdhsa_kernel standalone__mha_softmax__sampling_kernel
  .amdhsa_next_free_vgpr 216
  .amdhsa_next_free_sgpr 96
  .amdhsa_accum_offset 216
  .amdhsa_group_segment_fixed_size 0
  .amdhsa_kernarg_size 48
  .amdhsa_user_sgpr_count 2
  .amdhsa_user_sgpr_kernarg_segment_ptr 1
  .amdhsa_system_sgpr_workgroup_id_x 1
  .amdhsa_float_denorm_mode_32 3
.end_amdhsa_kernel
```
